```python
import torch

def _softmax(x, axis=-1):
    return torch.softmax(x, dim=axis)
def _gelu(x):
    return torch.nn.functional.gelu(x, approximate="tanh")
def _silu(x):
    return torch.nn.functional.silu(x)
def _sigmoid(x):
    return torch.sigmoid(x)
def _layernorm(x, axis=-1, eps=1e-5):
    m = x.mean(dim=axis, keepdim=True)
    v = x.var(dim=axis, keepdim=True, unbiased=False)
    return (x - m) / torch.sqrt(v + eps)
def _scatter_add(tgt, idx, src, axis=0):
    return tgt.clone().index_add_(axis, idx, src)
def _segment_sum(src, seg, n):
    out = torch.zeros((n,) + src.shape[1:], dtype=src.dtype)
    return out.index_add_(0, seg, src)
def _pad(x, pw):
    flat = tuple(v for pair in reversed(pw) for v in pair)
    return torch.nn.functional.pad(x, flat)

kernel_name = 'interleave_layers__sliding_block_cached__dense_activation_silu__decode'

def setup_inputs():

    _w = (lambda a: (lambda t: t.to(torch.bfloat16) if t.is_floating_point() else t)(torch.as_tensor(a)))
    def _A_setup():
        B, Sq, D = 4, 1, 512
        Hq, Hkv, Sk, Dh = 32, 8, 4096, 128
        assert Hq % Hkv == 0, (Hq, Hkv)
        return {
            "x": _w((lambda *s: torch.randn(*s, dtype=torch.bfloat16) * 0.1)(B, Sq, D)),
            "k_cache": _w((lambda *s: torch.randn(*s, dtype=torch.bfloat16) * 0.8)(B, Hkv, Sk, Dh)),
            "v_cache": _w((lambda *s: torch.randn(*s, dtype=torch.bfloat16) * 3.2)(B, Hkv, Sk, Dh)),
            "wq": _w((lambda *s: torch.randn(*s, dtype=torch.bfloat16) * 0.8)(D, Hq * Dh) * (D ** -0.5)),
            "wo": _w((lambda *s: torch.randn(*s, dtype=torch.bfloat16) * 3.2)(Hq * Dh, D) * ((Hq * Dh) ** -0.5)),
        }
    _A_in = _A_setup()

    def _B_setup():
        B, S, D, F = 4, 1, 512, 1792
        return {
            "x": _w((lambda *s: torch.randn(*s, dtype=torch.bfloat16) * 0.1)(B, S, D)),
            "w1": _w((lambda *s: torch.randn(*s, dtype=torch.bfloat16) * 1.6)(D, F) * (D ** -0.5)),
            "w2": _w((lambda *s: torch.randn(*s, dtype=torch.bfloat16) * 0.4)(F, D) * (F ** -0.5)),
        }
    _B_in = _B_setup()

    return {
        "A_x": _A_in["x"],
        "A_k_cache": _A_in["k_cache"],
        "A_v_cache": _A_in["v_cache"],
        "A_wq": _A_in["wq"],
        "A_wo": _A_in["wo"],
        "B_x": _B_in["x"],
        "B_w1": _B_in["w1"],
        "B_w2": _B_in["w2"],
    }

def reference(A_x, A_k_cache, A_v_cache, A_wq, A_wo, B_x, B_w1, B_w2):
    def _A_ref(x, k_cache, v_cache, wq, wo):
        B, Sq, D = x.shape
        Hq, Dh = 32, 128
        Hkv, Sk = k_cache.shape[1], k_cache.shape[2]
        W = min(4096, max(256, Sk // 4))
        rep = Hq // Hkv
        q = (lambda x, *d: x.permute(*d))((x @ wq).reshape(B, Sq, Hq, Dh), 0, 2, 1, 3)
        k = (lambda x, n, axis: torch.repeat_interleave(x, n, dim=axis))(k_cache[:, :, Sk - W:, :], rep, axis=1)
        v = (lambda x, n, axis: torch.repeat_interleave(x, n, dim=axis))(v_cache[:, :, Sk - W:, :], rep, axis=1)
        scores = torch.einsum("bhqd,bhkd->bhqk", q, k) * (Dh ** -0.5)
        p = _softmax(scores, axis=-1)
        o = torch.einsum("bhqk,bhkd->bhqd", p, v)
        return (lambda x, *d: x.permute(*d))(o, 0, 2, 1, 3).reshape(B, Sq, Hq * Dh) @ wo

    def _B_ref(x, w1, w2):
        h = torch.einsum("bsd,df->bsf", x, w1)
        h = _silu(h)
        out = torch.einsum("bsf,fd->bsd", h, w2)
        return out

    x = A_x
    x = x + _A_ref(_layernorm(x, axis=-1), A_k_cache, A_v_cache, A_wq, A_wo)
    x = x + _B_ref(_layernorm(x, axis=-1), B_w1, B_w2)
    x = x + _A_ref(_layernorm(x, axis=-1), A_k_cache, A_v_cache, A_wq, A_wo)
    x = x + _B_ref(_layernorm(x, axis=-1), B_w1, B_w2)
    return x
```

```asm
; @launch grid=(256,1,1) block=(512,1,1) lds=111616
.amdgcn_target "amdgcn-amd-amdhsa--gfx950"
.text
.globl interleave_layers__sliding_block_cached__dense_activation_silu__decode_kernel
.p2align 8
.type interleave_layers__sliding_block_cached__dense_activation_silu__decode_kernel,@function
interleave_layers__sliding_block_cached__dense_activation_silu__decode_kernel:
    s_cmp_ge_u32 s2, 0x100
    s_cbranch_scc1 L_END
    s_load_dwordx16 s[16:31], s[0:1], 0
    s_load_dwordx4 s[32:35], s[0:1], 64
    s_load_dwordx2 s[36:37], s[0:1], 80
    v_lshrrev_b32 v4, 6, v0
    s_lshr_b32 s4, s2, 3
    s_and_b32 s3, s2, 7
    v_readfirstlane_b32 s5, v4
    v_and_b32 v1, 63, v0
    v_and_b32 v2, 15, v0
    v_bfe_u32 v3, v0, 4, 2
    s_cmp_lt_u32 s4, 16
    s_cbranch_scc1 L_ROLE_A
L_ROLE_B:
    s_getpc_b64 s[12:13]
    v_lshlrev_b32 v158, 5, v0
    v_min_u32 v158, L_END - L_ROLE_B - 16, v158
    v_mov_b32 v159, s13
    v_add_co_u32 v158, vcc, s12, v158
    s_nop 1
    v_addc_co_u32 v159, vcc, 0, v159, vcc
    global_load_dword v179, v[158:159], off
    s_sub_u32 s64, s4, 16
    v_lshlrev_b32 v156, 4, v1
    s_lshl_b32 s65, s3, 10
    s_lshl_b32 s9, s64, 18
    s_add_u32 s8, s65, s9
    s_lshl_b32 s9, s5, 15
    s_add_u32 s8, s8, s9
    s_mov_b32 s50, 4194304
    s_mov_b32 s51, 0x20000
    s_lshl_b32 s70, s5, 4
    s_or_b32 s70, s70, s64
    s_cmp_eq_u32 s70, 7
    s_waitcnt lgkmcnt(0)
    s_mov_b32 s48, s22
    s_mov_b32 s49, s23
    s_cbranch_scc1 L_B_SP0
L_B_NOL:
    buffer_load_dwordx4 v[196:199], v156, s[48:51], s8 offen
    s_add_u32 s8, s8, 0x2000
    buffer_load_dwordx4 v[200:203], v156, s[48:51], s8 offen
    s_add_u32 s8, s8, 0x2000
    buffer_load_dwordx4 v[204:207], v156, s[48:51], s8 offen
    s_add_u32 s8, s8, 0x2000
    buffer_load_dwordx4 v[208:211], v156, s[48:51], s8 offen
    s_branch L_B1
L_B_SP0:
    s_mov_b32 s40, s36
    s_mov_b32 s41, s37
    s_mov_b32 s42, 0x1e8000
    s_mov_b32 s43, 0x20000
    v_mov_b32 v160, -1
    v_mov_b32 v161, -1
    v_mov_b32 v162, -1
    v_mov_b32 v163, -1
    s_lshl_b32 s66, s3, 12
    buffer_store_dwordx4 v[160:163], v156, s[40:43], s66 offen
    buffer_store_dwordx4 v[160:163], v156, s[40:43], s66 offen offset:1024
    buffer_store_dwordx4 v[160:163], v156, s[40:43], s66 offen offset:2048
    buffer_store_dwordx4 v[160:163], v156, s[40:43], s66 offen offset:3072
    s_mov_b32 s60, s34
    s_mov_b32 s61, s35
    s_movk_i32 s62, 0x100
    s_mov_b32 s63, 0x20000
    s_nop 0
    v_mov_b32 v165, 0
    s_movk_i32 s46, 0x100
    s_mov_b32 s47, 0x20000
    s_lshl_b32 s66, s3, 19
    s_add_u32 s44, s24, s66
    s_addc_u32 s45, s25, 0
    buffer_load_dword v179, v165, s[44:47], 0 offen
    s_mov_b32 s44, s28
    s_mov_b32 s45, s29
    buffer_load_dword v179, v165, s[44:47], 0 offen
    s_mov_b32 s44, s30
    s_mov_b32 s45, s31
    buffer_load_dword v179, v165, s[44:47], 0 offen
    s_mov_b32 s44, s32
    s_mov_b32 s45, s33
    buffer_load_dword v179, v165, s[44:47], 0 offen
    buffer_load_dword v179, v165, s[60:63], 0 offen
    s_branch L_B_NOL
L_ROLE_A:
    s_lshr_b32 s8, s4, 2
    s_lshl_b32 s8, s8, 3
    s_add_u32 s8, s8, s3
    s_lshl_b32 s64, s8, 20
    s_and_b32 s8, s4, 3
    s_lshl_b32 s8, s8, 16
    s_add_u32 s64, s64, s8
    s_and_b32 s9, s5, 3
    s_lshl_b32 s9, s9, 14
    s_add_u32 s64, s64, s9
    s_add_u32 s64, s64, 0xC0000
    s_mov_b32 s50, 33554432
    s_mov_b32 s51, 0x20000
    s_cmp_lt_u32 s5, 4
    s_cbranch_scc1 L_A_V
    s_setprio 3
    v_xor_b32 v4, v3, v2
    v_lshlrev_b32 v4, 4, v4
    v_lshl_add_u32 v4, v3, 8, v4
    s_mov_b32 m0, s9
    s_waitcnt lgkmcnt(0)
    s_mov_b32 s48, s18
    s_mov_b32 s49, s19
    buffer_load_dwordx4 v4, s[48:51], s64 offen offset:0 nt lds
    buffer_load_dwordx4 v4, s[48:51], s64 offen offset:1024 nt lds
    buffer_load_dwordx4 v4, s[48:51], s64 offen offset:2048 nt lds
    buffer_load_dwordx4 v4, s[48:51], s64 offen offset:3072 nt lds
    s_add_u32 s9, s9, 0x1000
    s_mov_b32 m0, s9
    s_add_u32 s64, s64, 0x1000
    buffer_load_dwordx4 v4, s[48:51], s64 offen offset:0 nt lds
    buffer_load_dwordx4 v4, s[48:51], s64 offen offset:1024 nt lds
    buffer_load_dwordx4 v4, s[48:51], s64 offen offset:2048 nt lds
    buffer_load_dwordx4 v4, s[48:51], s64 offen offset:3072 nt lds
    s_add_u32 s9, s9, 0x1000
    s_mov_b32 m0, s9
    s_add_u32 s64, s64, 0x1000
    buffer_load_dwordx4 v4, s[48:51], s64 offen offset:0 nt lds
    buffer_load_dwordx4 v4, s[48:51], s64 offen offset:1024 nt lds
    buffer_load_dwordx4 v4, s[48:51], s64 offen offset:2048 nt lds
    buffer_load_dwordx4 v4, s[48:51], s64 offen offset:3072 nt lds
    s_add_u32 s9, s9, 0x1000
    s_mov_b32 m0, s9
    s_add_u32 s64, s64, 0x1000
    buffer_load_dwordx4 v4, s[48:51], s64 offen offset:0 nt lds
    buffer_load_dwordx4 v4, s[48:51], s64 offen offset:1024 nt lds
    buffer_load_dwordx4 v4, s[48:51], s64 offen offset:2048 nt lds
    buffer_load_dwordx4 v4, s[48:51], s64 offen offset:3072 nt lds
    s_barrier
    s_branch L_A1
L_A_V:
    v_lshlrev_b32 v5, 4, v2
    v_and_b32 v6, 16, v0
    v_lshl_add_u32 v5, v6, 8, v5
    v_and_b32 v6, 32, v0
    v_lshl_add_u32 v5, v6, 5, v5
    s_add_u32 s65, s64, 0x2000
    v_lshlrev_b32 v7, 2, v1
    v_add_u32 v7, 0x10000, v7
    v_mov_b32 v8, -1
    v_mov_b32 v9, 0
    ds_write2st64_b32 v7, v8, v9 offset0:0 offset1:1
    s_waitcnt lgkmcnt(0)
    s_mov_b32 s48, s20
    s_mov_b32 s49, s21
    s_barrier
    buffer_load_dwordx4 v[80:83], v5, s[48:51], s64 offen offset:0 nt
    buffer_load_dwordx4 v[84:87], v5, s[48:51], s64 offen offset:256 nt
    buffer_load_dwordx4 v[88:91], v5, s[48:51], s65 offen offset:0 nt
    buffer_load_dwordx4 v[92:95], v5, s[48:51], s65 offen offset:256 nt
    buffer_load_dwordx4 v[96:99], v5, s[48:51], s64 offen offset:512 nt
    buffer_load_dwordx4 v[100:103], v5, s[48:51], s64 offen offset:768 nt
    buffer_load_dwordx4 v[104:107], v5, s[48:51], s65 offen offset:512 nt
    buffer_load_dwordx4 v[108:111], v5, s[48:51], s65 offen offset:768 nt
    buffer_load_dwordx4 v[112:115], v5, s[48:51], s64 offen offset:2048 nt
    buffer_load_dwordx4 v[116:119], v5, s[48:51], s64 offen offset:2304 nt
    buffer_load_dwordx4 v[120:123], v5, s[48:51], s65 offen offset:2048 nt
    buffer_load_dwordx4 v[124:127], v5, s[48:51], s65 offen offset:2304 nt
    buffer_load_dwordx4 v[128:131], v5, s[48:51], s64 offen offset:2560 nt
    buffer_load_dwordx4 v[132:135], v5, s[48:51], s64 offen offset:2816 nt
    buffer_load_dwordx4 v[136:139], v5, s[48:51], s65 offen offset:2560 nt
    buffer_load_dwordx4 v[140:143], v5, s[48:51], s65 offen offset:2816 nt
    s_branch L_A1
L_A1:
    s_mov_b32 s6, 0
    s_mov_b32 s38, 0x05040100
    s_mov_b32 s39, 0x07060302
    s_mov_b32 s40, s36
    s_mov_b32 s41, s37
    s_mov_b32 s42, 0x1e8000
    s_mov_b32 s43, 0x20000
    s_mov_b32 s60, s34
    s_mov_b32 s61, s35
    s_mov_b32 s62, 0x100
    s_mov_b32 s63, 0x20000
    s_lshl_b32 s11, s3, 2
    v_mov_b32 v6, 0
    v_mov_b32 v236, 0x10100
    v_lshl_add_u32 v237, v1, 4, v236
    v_and_b32 v220, 3, v2
    v_lshlrev_b32 v220, 4, v220
    v_lshl_add_u32 v221, v3, 6, v220
    v_lshrrev_b32 v222, 2, v2
    v_lshl_add_u32 v11, v222, 8, v221
    s_lshl_b32 s66, s3, 12
    s_lshr_b32 s8, s4, 2
    s_lshl_b32 s8, s8, 10
    s_add_u32 s66, s66, s8
    s_cmp_ge_u32 s5, 4
    s_cbranch_scc1 L_A_HELP
    s_lshl_b32 s9, s5, 14
    v_lshl_add_u32 v220, v2, 8, v221
    v_add_u32 v7, s9, v220
    v_xor_b32 v8, 16, v7
    v_xor_b32 v9, 32, v7
    v_xor_b32 v10, 48, v7
    v_lshlrev_b32 v12, 3, v1
    v_add_u32 v12, s9, v12
    s_lshl_b32 s8, s5, 2
    s_add_u32 s8, s8, 0x10000
    v_lshlrev_b32 v13, 4, v222
    v_add_u32 v13, s8, v13
    v_lshlrev_b32 v15, 4, v3
    v_add_u32 v15, s8, v15
    s_mov_b32 s72, 0x3e0293ee
    s_mov_b32 s76, 0xaaaaaaaa
    s_mov_b32 s77, 0xaaaaaaaa
    v_mov_b32 v216, 0x3f803f80
    v_mov_b32 v217, 0x3f803f80
    v_mov_b32 v218, 0x3f803f80
    v_mov_b32 v219, 0x3f803f80
    v_and_b32 v238, 1, v1
    v_mul_u32_u24 v238, 0xaaaa, v238
    v_add_u32 v238, 0x4444, v238
    s_lshl_b32 s8, s5, 2
    v_add_u32 v223, s8, v236
    s_mov_b32 s7, 0
L_A_KW:
    ds_read_b32 v239, v223 offset:16
    s_add_u32 s7, s7, 1
    s_cmp_gt_u32 s7, 0x800000
    s_cbranch_scc1 L_END
    s_waitcnt lgkmcnt(0)
    v_cmp_eq_u32 vcc, 0, v239
    s_cbranch_vccnz L_A_KW
    ds_read_b128 v[16:19], v7 offset:0
    ds_read_b128 v[20:23], v8 offset:0
    ds_read_b128 v[24:27], v9 offset:0
    ds_read_b128 v[28:31], v10 offset:0
    ds_read_b128 v[32:35], v7 offset:4096
    ds_read_b128 v[36:39], v8 offset:4096
    ds_read_b128 v[40:43], v9 offset:4096
    ds_read_b128 v[44:47], v10 offset:4096
    ds_read_b128 v[48:51], v7 offset:8192
    ds_read_b128 v[52:55], v8 offset:8192
    ds_read_b128 v[56:59], v9 offset:8192
    ds_read_b128 v[60:63], v10 offset:8192
    ds_read_b128 v[64:67], v7 offset:12288
    ds_read_b128 v[68:71], v8 offset:12288
    ds_read_b128 v[72:75], v9 offset:12288
    ds_read_b128 v[76:79], v10 offset:12288
    s_waitcnt vmcnt(14)
    v_perm_b32 v144, v84, v80, s38
    v_perm_b32 v152, v84, v80, s39
    v_perm_b32 v160, v85, v81, s38
    v_perm_b32 v168, v85, v81, s39
    v_perm_b32 v176, v86, v82, s38
    v_perm_b32 v184, v86, v82, s39
    v_perm_b32 v192, v87, v83, s38
    v_perm_b32 v200, v87, v83, s39
    s_waitcnt vmcnt(12)
    v_perm_b32 v145, v92, v88, s38
    v_perm_b32 v153, v92, v88, s39
    v_perm_b32 v161, v93, v89, s38
    v_perm_b32 v169, v93, v89, s39
    v_perm_b32 v177, v94, v90, s38
    v_perm_b32 v185, v94, v90, s39
    v_perm_b32 v193, v95, v91, s38
    v_perm_b32 v201, v95, v91, s39
    s_waitcnt vmcnt(10)
    v_perm_b32 v146, v100, v96, s38
    v_perm_b32 v154, v100, v96, s39
    v_perm_b32 v162, v101, v97, s38
    v_perm_b32 v170, v101, v97, s39
    v_perm_b32 v178, v102, v98, s38
    v_perm_b32 v186, v102, v98, s39
    v_perm_b32 v194, v103, v99, s38
    v_perm_b32 v202, v103, v99, s39
    ds_read_b32 v239, v236 offset:4
    s_waitcnt lgkmcnt(0)
    v_readfirstlane_b32 s67, v239
    s_cmp_eq_u32 s67, 1
    s_cselect_b32 s67, s66, 0x40000000
    s_cbranch_scc0 OL_1
    buffer_load_dwordx4 v[228:231], v11, s[40:43], s66 offen sc1
OL_1:
    s_waitcnt vmcnt(8)
    v_perm_b32 v147, v108, v104, s38
    v_perm_b32 v155, v108, v104, s39
    v_perm_b32 v163, v109, v105, s38
    v_perm_b32 v171, v109, v105, s39
    v_perm_b32 v179, v110, v106, s38
    v_perm_b32 v187, v110, v106, s39
    v_perm_b32 v195, v111, v107, s38
    v_perm_b32 v203, v111, v107, s39
    s_mov_b32 s12, 0
L_A_QE:
    ds_read_b32 v239, v236
    ds_read_b128 v[208:211], v237 offset:256
    s_waitcnt lgkmcnt(0)
    v_cmp_eq_u32 vcc, 0, v239
    s_cbranch_vccz L_A_GOTQ
    s_getreg_b32 s8, hwreg(HW_REG_IB_STS, 0, 4)
    s_cmp_gt_u32 s8, 5
    s_cbranch_scc1 L_A_QE
    s_waitcnt vmcnt(6)
    v_perm_b32 v148, v116, v112, s38
    v_perm_b32 v156, v116, v112, s39
    v_perm_b32 v164, v117, v113, s38
    v_perm_b32 v172, v117, v113, s39
    v_perm_b32 v180, v118, v114, s38
    v_perm_b32 v188, v118, v114, s39
    v_perm_b32 v196, v119, v115, s38
    v_perm_b32 v204, v119, v115, s39
    s_waitcnt vmcnt(4)
    v_perm_b32 v149, v124, v120, s38
    v_perm_b32 v157, v124, v120, s39
    v_perm_b32 v165, v125, v121, s38
    v_perm_b32 v173, v125, v121, s39
    v_perm_b32 v181, v126, v122, s38
    v_perm_b32 v189, v126, v122, s39
    v_perm_b32 v197, v127, v123, s38
    v_perm_b32 v205, v127, v123, s39
    s_waitcnt vmcnt(2)
    v_perm_b32 v150, v132, v128, s38
    v_perm_b32 v158, v132, v128, s39
    v_perm_b32 v166, v133, v129, s38
    v_perm_b32 v174, v133, v129, s39
    v_perm_b32 v182, v134, v130, s38
    v_perm_b32 v190, v134, v130, s39
    v_perm_b32 v198, v135, v131, s38
    v_perm_b32 v206, v135, v131, s39
    s_waitcnt vmcnt(0)
    v_perm_b32 v151, v140, v136, s38
    v_perm_b32 v159, v140, v136, s39
    v_perm_b32 v167, v141, v137, s38
    v_perm_b32 v175, v141, v137, s39
    v_perm_b32 v183, v142, v138, s38
    v_perm_b32 v191, v142, v138, s39
    v_perm_b32 v199, v143, v139, s38
    v_perm_b32 v207, v143, v139, s39
    s_mov_b32 s12, 1
    s_mov_b32 s7, 0
L_A_QW:
    s_getreg_b32 s8, hwreg(HW_REG_IB_STS, 0, 4)
    s_cmp_lg_u32 s8, 0
    s_cbranch_scc1 L_A_QL
    s_cmp_lg_u32 s67, s66
    s_cbranch_scc1 L_A_QR
    s_waitcnt vmcnt(0)
    v_max3_u32 v220, v228, v229, v230
    v_max_u32 v220, v220, v231
    v_cmp_eq_u32 vcc, -1, v220
    v_mov_b32 v208, v228
    v_mov_b32 v209, v229
    v_mov_b32 v210, v230
    v_mov_b32 v211, v231
    s_cbranch_vccz L_A_GOTQ
L_A_QR:
    ds_read_b32 v239, v236 offset:4
    s_waitcnt lgkmcnt(0)
    v_readfirstlane_b32 s67, v239
    s_cmp_eq_u32 s67, 1
    s_cselect_b32 s67, s66, 0x40000000
    s_cbranch_scc0 OL_2
    buffer_load_dwordx4 v[228:231], v11, s[40:43], s66 offen sc1
OL_2:
L_A_QL:
    ds_read_b32 v239, v236
    ds_read_b128 v[208:211], v237 offset:256
    s_add_u32 s7, s7, 1
    s_cmp_gt_u32 s7, 0x800000
    s_cbranch_scc1 L_END
    s_waitcnt lgkmcnt(0)
    v_cmp_eq_u32 vcc, 0, v239
    s_cbranch_vccnz L_A_QW
    s_branch L_A_GOTQ
L_A_LOOP:
    s_mov_b32 s7, 0
    s_add_u32 s10, s66, s14
POLL_3:
    buffer_load_dwordx4 v[208:211], v11, s[40:43], s10 offen sc1
    s_add_u32 s7, s7, 1
    s_and_b32 s8, s7, s13
    s_cmp_eq_u32 s8, s13
    s_cselect_b32 s8, 0x31000, 0
    s_add_u32 s10, s66, s8
    s_cmp_gt_u32 s7, 0x200000
    s_cbranch_scc1 L_END
    s_waitcnt vmcnt(0)
    v_max3_u32 v220, v208, v209, v210
    v_max_u32 v220, v220, v211
    v_cmp_eq_u32 vcc, -1, v220
    s_cbranch_vccnz POLL_3
L_A_GOTQ:
    v_mov_b32_dpp v80, v208 quad_perm:[0,0,0,0] row_mask:0xf bank_mask:0xf
    v_mov_b32_dpp v81, v209 quad_perm:[0,0,0,0] row_mask:0xf bank_mask:0xf
    v_mov_b32_dpp v82, v210 quad_perm:[0,0,0,0] row_mask:0xf bank_mask:0xf
    v_mov_b32_dpp v83, v211 quad_perm:[0,0,0,0] row_mask:0xf bank_mask:0xf
    v_mov_b32_dpp v84, v208 quad_perm:[1,1,1,1] row_mask:0xf bank_mask:0xf
    v_mov_b32_dpp v85, v209 quad_perm:[1,1,1,1] row_mask:0xf bank_mask:0xf
    v_mfma_f32_16x16x32_bf16 v[96:99], v[16:19], v[80:83], 0
    v_mov_b32_dpp v86, v210 quad_perm:[1,1,1,1] row_mask:0xf bank_mask:0xf
    v_mov_b32_dpp v87, v211 quad_perm:[1,1,1,1] row_mask:0xf bank_mask:0xf
    v_mfma_f32_16x16x32_bf16 v[104:107], v[48:51], v[80:83], 0
    v_mov_b32_dpp v88, v208 quad_perm:[2,2,2,2] row_mask:0xf bank_mask:0xf
    v_mov_b32_dpp v89, v209 quad_perm:[2,2,2,2] row_mask:0xf bank_mask:0xf
    v_mfma_f32_16x16x32_bf16 v[96:99], v[20:23], v[84:87], v[96:99]
    v_mov_b32_dpp v90, v210 quad_perm:[2,2,2,2] row_mask:0xf bank_mask:0xf
    v_mov_b32_dpp v91, v211 quad_perm:[2,2,2,2] row_mask:0xf bank_mask:0xf
    v_mfma_f32_16x16x32_bf16 v[104:107], v[52:55], v[84:87], v[104:107]
    v_mov_b32_dpp v92, v208 quad_perm:[3,3,3,3] row_mask:0xf bank_mask:0xf
    v_mov_b32_dpp v93, v209 quad_perm:[3,3,3,3] row_mask:0xf bank_mask:0xf
    v_mfma_f32_16x16x32_bf16 v[96:99], v[24:27], v[88:91], v[96:99]
    v_mov_b32_dpp v94, v210 quad_perm:[3,3,3,3] row_mask:0xf bank_mask:0xf
    v_mov_b32_dpp v95, v211 quad_perm:[3,3,3,3] row_mask:0xf bank_mask:0xf
    v_mfma_f32_16x16x32_bf16 v[104:107], v[56:59], v[88:91], v[104:107]
    v_mov_b32 v240, 0
    v_mov_b32 v241, 0
    v_mfma_f32_16x16x32_bf16 v[96:99], v[28:31], v[92:95], v[96:99]
    v_mov_b32 v244, 0
    v_mov_b32 v245, 0
    v_mfma_f32_16x16x32_bf16 v[104:107], v[60:63], v[92:95], v[104:107]
    v_mov_b32 v248, 0
    v_mov_b32 v249, 0
    v_mfma_f32_16x16x32_bf16 v[100:103], v[32:35], v[80:83], 0
    v_mov_b32 v252, 0
    v_mov_b32 v253, 0
    v_mfma_f32_16x16x32_bf16 v[108:111], v[64:67], v[80:83], 0
    v_mfma_f32_16x16x32_bf16 v[100:103], v[36:39], v[84:87], v[100:103]
    v_mfma_f32_16x16x32_bf16 v[108:111], v[68:71], v[84:87], v[108:111]
    v_mfma_f32_16x16x32_bf16 v[100:103], v[40:43], v[88:91], v[100:103]
    v_cndmask_b32 v96, v96, v104, s[76:77]
    v_cndmask_b32 v97, v97, v105, s[76:77]
    v_mfma_f32_16x16x32_bf16 v[108:111], v[72:75], v[88:91], v[108:111]
    v_cndmask_b32 v98, v98, v106, s[76:77]
    v_cndmask_b32 v99, v99, v107, s[76:77]
    v_mfma_f32_16x16x32_bf16 v[100:103], v[44:47], v[92:95], v[100:103]
    v_max3_f32 v220, v96, v97, v98
    v_max_f32 v220, v220, v99
    v_mfma_f32_16x16x32_bf16 v[108:111], v[76:79], v[92:95], v[108:111]
    v_mov_b32 v80, 0
    v_mov_b32 v81, 0
    v_mov_b32 v84, 0
    v_mov_b32 v85, 0
    v_mov_b32 v88, 0
    v_mov_b32 v89, 0
    v_mov_b32 v92, 0
    v_mov_b32 v93, 0
    v_cndmask_b32 v100, v100, v108, s[76:77]
    v_cndmask_b32 v101, v101, v109, s[76:77]
    v_cndmask_b32 v102, v102, v110, s[76:77]
    v_cndmask_b32 v103, v103, v111, s[76:77]
    v_max3_f32 v221, v100, v101, v102
    v_max3_f32 v220, v220, v221, v103
    v_max_f32 v221, v220, v221
    s_nop 1
    v_permlane32_swap_b32 v220, v221
    v_max_f32 v222, v220, v221
    v_max_f32 v221, v220, v221
    s_nop 1
    v_permlane16_swap_b32 v222, v221
    v_max_f32 v220, v222, v221
    s_nop 1
    v_max_f32_dpp v220, v220, v220 quad_perm:[1,0,3,2] row_mask:0xf bank_mask:0xf
    v_mul_f32 v220, s72, v220
    v_fma_f32 v96, v96, s72, -v220
    v_min_u32 v221, -2, v220
    ds_write_b32 v13, v221
    v_fma_f32 v97, v97, s72, -v220
    v_fma_f32 v98, v98, s72, -v220
    v_fma_f32 v99, v99, s72, -v220
    v_fma_f32 v100, v100, s72, -v220
    v_fma_f32 v101, v101, s72, -v220
    v_fma_f32 v102, v102, s72, -v220
    v_fma_f32 v103, v103, s72, -v220
    v_exp_f32 v96, v96
    v_exp_f32 v97, v97
    v_exp_f32 v98, v98
    v_exp_f32 v99, v99
    v_exp_f32 v100, v100
    v_exp_f32 v101, v101
    v_exp_f32 v102, v102
    v_exp_f32 v103, v103
    v_cvt_pk_bf16_f32 v208, v96, v97
    v_cvt_pk_bf16_f32 v209, v98, v99
    v_cvt_pk_bf16_f32 v210, v100, v101
    v_cvt_pk_bf16_f32 v211, v102, v103
    s_cmp_eq_u32 s12, 0
    s_cbranch_scc1 L_A_VLATE
L_A_VOK:
    v_smfmac_f32_16x16x64_bf16 v[80:83], v[208:211], v[144:151], v238
    v_smfmac_f32_16x16x64_bf16 v[84:87], v[208:211], v[152:159], v238
    v_smfmac_f32_16x16x64_bf16 v[88:91], v[208:211], v[160:167], v238
    v_smfmac_f32_16x16x64_bf16 v[92:95], v[208:211], v[168:175], v238
    v_smfmac_f32_16x16x64_bf16 v[240:243], v[208:211], v[176:183], v238
    v_smfmac_f32_16x16x64_bf16 v[244:247], v[208:211], v[184:191], v238
    v_smfmac_f32_16x16x64_bf16 v[248:251], v[208:211], v[192:199], v238
    v_smfmac_f32_16x16x64_bf16 v[252:255], v[208:211], v[200:207], v238
    v_mfma_f32_16x16x32_bf16 v[212:215], v[208:211], v[216:219], 0
    v_add_f32 v96, v80, v81
    v_add_f32 v97, v84, v85
    ds_write_b64 v12, v[96:97] offset:0
    v_add_f32 v98, v88, v89
    v_add_f32 v99, v92, v93
    ds_write_b64 v12, v[98:99] offset:576
    v_add_f32 v100, v240, v241
    v_add_f32 v101, v244, v245
    ds_write_b64 v12, v[100:101] offset:1152
    v_add_f32 v102, v248, v249
    v_add_f32 v103, v252, v253
    ds_write_b64 v12, v[102:103] offset:1728
    v_add_f32 v212, v212, v213
    ds_write_b32 v15, v212 offset:64
    s_waitcnt lgkmcnt(0)
    s_barrier
    s_barrier
    s_cmp_lg_u32 s6, 0
    s_cbranch_scc1 L_A_NEXT
    s_mov_b32 s7, 0
FLAG_4:
    buffer_load_dword v239, v6, s[60:63], s11 offen offset:64 sc1
    s_add_u32 s7, s7, 1
    s_cmp_gt_u32 s7, 0x200000
    s_cbranch_scc1 L_END
    s_waitcnt vmcnt(0)
    v_cmp_gt_u32 vcc, 1, v239
    s_cbranch_vccz FLAGD_5
    s_sleep 1
    s_and_b32 s8, s7, 255
    s_cbranch_scc1 FLAG_4
    buffer_load_dword v239, v6, s[60:63], 0 offen offset:128 sc1
    s_waitcnt vmcnt(0)
    v_cmp_ne_u32 vcc, 64, v239
    s_cbranch_vccnz FLAG_4
FLAGD_5:
    v_readfirstlane_b32 s8, v239
    s_getreg_b32 s9, hwreg(HW_REG_XCC_ID, 0, 4)
    s_add_u32 s9, s9, 1
    s_cmp_eq_u32 s8, s9
    s_cselect_b32 s13, 0xff, 0
    s_cselect_b32 s14, 0, 0x31000
    s_cselect_b32 s15, 0, 0x40000000
    s_mov_b32 s7, 0
FLAG_6:
    buffer_load_dword v239, v6, s[60:63], s11 offen offset:96 sc1
    s_add_u32 s7, s7, 1
    s_cmp_gt_u32 s7, 0x200000
    s_cbranch_scc1 L_END
    s_waitcnt vmcnt(0)
    v_cmp_gt_u32 vcc, 2, v239
    s_cbranch_vccz FLAGD_7
    s_sleep 1
    s_and_b32 s8, s7, 255
    s_or_b32 s8, s8, s13
    s_cbranch_scc1 FLAG_6
    buffer_load_dword v239, v6, s[60:63], 0 offen offset:128 sc1
    s_waitcnt vmcnt(0)
    v_cmp_ne_u32 vcc, 64, v239
    s_cbranch_vccnz FLAG_6
FLAGD_7:
    s_add_u32 s8, s66, 0xf4000
    buffer_load_dwordx4 v[208:211], v11, s[40:43], s8 offen sc1
    s_branch L_A_NEXT
L_A_VLATE:
    s_waitcnt vmcnt(6)
    v_perm_b32 v148, v116, v112, s38
    v_perm_b32 v156, v116, v112, s39
    v_perm_b32 v164, v117, v113, s38
    v_perm_b32 v172, v117, v113, s39
    v_perm_b32 v180, v118, v114, s38
    v_perm_b32 v188, v118, v114, s39
    v_perm_b32 v196, v119, v115, s38
    v_perm_b32 v204, v119, v115, s39
    s_waitcnt vmcnt(4)
    v_perm_b32 v149, v124, v120, s38
    v_perm_b32 v157, v124, v120, s39
    v_perm_b32 v165, v125, v121, s38
    v_perm_b32 v173, v125, v121, s39
    v_perm_b32 v181, v126, v122, s38
    v_perm_b32 v189, v126, v122, s39
    v_perm_b32 v197, v127, v123, s38
    v_perm_b32 v205, v127, v123, s39
    s_waitcnt vmcnt(2)
    v_perm_b32 v150, v132, v128, s38
    v_perm_b32 v158, v132, v128, s39
    v_perm_b32 v166, v133, v129, s38
    v_perm_b32 v174, v133, v129, s39
    v_perm_b32 v182, v134, v130, s38
    v_perm_b32 v190, v134, v130, s39
    v_perm_b32 v198, v135, v131, s38
    v_perm_b32 v206, v135, v131, s39
    s_waitcnt vmcnt(0)
    v_perm_b32 v151, v140, v136, s38
    v_perm_b32 v159, v140, v136, s39
    v_perm_b32 v167, v141, v137, s38
    v_perm_b32 v175, v141, v137, s39
    v_perm_b32 v183, v142, v138, s38
    v_perm_b32 v191, v142, v138, s39
    v_perm_b32 v199, v143, v139, s38
    v_perm_b32 v207, v143, v139, s39
    s_mov_b32 s12, 1
    s_nop 0
    s_branch L_A_VOK
L_A_HELP:
    s_mov_b32 s44, s16
    s_mov_b32 s45, s17
    s_mov_b32 s46, 0x1000
    s_mov_b32 s47, 0x20000
    s_mov_b32 s56, s32
    s_mov_b32 s57, s33
    s_mov_b32 s58, 0x1000
    s_mov_b32 s59, 0x20000
    s_and_b32 s8, s5, 3
    s_lshl_b32 s9, s8, 4
    s_add_u32 s9, s9, 0x10000
    v_mov_b32 v14, s9
    v_lshrrev_b32 v220, 2, v1
    v_and_b32 v221, 3, v1
    v_mul_u32_u24 v68, 576, v221
    v_lshl_add_u32 v68, v220, 3, v68
    s_lshl_b32 s9, s8, 7
    v_add_u32 v68, s9, v68
    v_lshlrev_b32 v69, 8, v220
    v_lshl_add_u32 v69, v221, 2, v69
    s_lshl_b32 s67, s3, 14
    s_lshl_b32 s9, s8, 12
    s_add_u32 s67, s67, s9
    s_lshl_b32 s9, s4, 4
    s_add_u32 s67, s67, s9
    s_add_u32 s67, s67, 0x8000
    v_add_u32 v69, s67, v69
    s_lshl_b32 s67, s3, 8
    s_lshl_b32 s9, s8, 6
    s_add_u32 s67, s67, s9
    s_lshl_b32 s9, s4, 2
    s_add_u32 s67, s67, s9
    s_add_u32 s67, s67, 0x28000
    v_mov_b32 v70, s67
    v_and_b32 v220, 63, v1
    v_mov_b32 v221, 0x40000000
    v_cmp_eq_u32 vcc, 0, v220
    s_nop 1
    v_cndmask_b32 v70, v221, v70, vcc
    v_and_b32 v220, 3, v1
    v_mov_b32 v221, 0x40000000
    v_cmp_eq_u32 vcc, 0, v220
    s_nop 1
    v_cndmask_b32 v75, v221, v69, vcc
    s_lshl_b32 s73, s4, 1
    s_and_b32 s8, s5, 1
    s_add_u32 s73, s73, s8
    s_and_b32 s8, s73, 6
    s_lshl_b32 s68, s8, 13
    s_and_b32 s8, s73, 1
    s_lshl_b32 s8, s8, 12
    s_add_u32 s68, s68, s8
    s_lshr_b32 s9, s73, 3
    s_lshl_b32 s9, s9, 6
    s_add_u32 s68, s68, s9
    s_add_u32 s68, s68, 0x64000
    s_lshl_b32 s69, s73, 14
    s_add_u32 s69, s69, 0x74000
    s_lshl_b32 s71, s73, 7
    v_lshrrev_b32 v220, 5, v1
    v_lshlrev_b32 v71, 11, v220
    v_bfe_u32 v220, v1, 3, 2
    v_lshl_add_u32 v71, v220, 8, v71
    v_bfe_u32 v220, v1, 2, 1
    v_lshl_add_u32 v71, v220, 10, v71
    v_and_b32 v220, 3, v1
    v_lshl_add_u32 v71, v220, 4, v71
    v_and_b32 v220, 7, v1
    v_lshlrev_b32 v72, 4, v1
    v_lshlrev_b32 v73, 4, v220
    v_and_b32 v221, 1, v3
    v_lshl_add_u32 v73, v221, 3, v73
    v_and_b32 v222, 1, v220
    v_lshlrev_b32 v222, 4, v222
    v_mov_b32 v223, 0x3f80
    v_lshlrev_b32 v222, v222, v223
    v_lshrrev_b32 v223, 1, v220
    v_cmp_eq_u32 vcc, 0, v223
    s_nop 1
    v_cndmask_b32 v48, 0, v222, vcc
    v_cmp_eq_u32 vcc, 1, v223
    s_nop 1
    v_cndmask_b32 v49, 0, v222, vcc
    v_cmp_eq_u32 vcc, 2, v223
    s_nop 1
    v_cndmask_b32 v50, 0, v222, vcc
    v_cmp_eq_u32 vcc, 3, v223
    s_nop 1
    v_cndmask_b32 v51, 0, v222, vcc
    s_lshl_b32 s8, s5, 2
    v_add_u32 v223, s8, v236
    s_waitcnt vmcnt(0)
    ds_write_b32 v223, v236
    s_cmp_ge_u32 s5, 6
    s_cbranch_scc1 L_A_HP
    s_mov_b32 s7, 0
LM_8:
    s_sleep 2
    ds_read_b32 v239, v236 offset:4
    s_add_u32 s7, s7, 1
    s_cmp_gt_u32 s7, 0x800000
    s_cbranch_scc1 L_END
    s_waitcnt lgkmcnt(0)
    v_readfirstlane_b32 s8, v239
    s_cmp_eq_u32 s8, 0
    s_cbranch_scc1 LM_8
    s_cmp_eq_u32 s8, 1
    s_cselect_b32 s13, 0xff, 0
    s_cselect_b32 s14, 0, 0x31000
    s_cselect_b32 s15, 0, 0x40000000
    s_branch L_A_HGO
L_A_HP:
    s_mov_b32 s7, 0
FLAG_9:
    buffer_load_dword v239, v6, s[60:63], s11 offen offset:64 sc1
    s_add_u32 s7, s7, 1
    s_cmp_gt_u32 s7, 0x200000
    s_cbranch_scc1 L_END
    s_waitcnt vmcnt(0)
    v_cmp_gt_u32 vcc, 1, v239
    s_cbranch_vccz FLAGD_10
    s_sleep 1
    s_and_b32 s8, s7, 255
    s_cbranch_scc1 FLAG_9
    buffer_load_dword v239, v6, s[60:63], 0 offen offset:128 sc1
    s_waitcnt vmcnt(0)
    v_cmp_ne_u32 vcc, 64, v239
    s_cbranch_vccnz FLAG_9
FLAGD_10:
    v_readfirstlane_b32 s8, v239
    s_getreg_b32 s9, hwreg(HW_REG_XCC_ID, 0, 4)
    s_add_u32 s9, s9, 1
    s_cmp_eq_u32 s8, s9
    s_cselect_b32 s13, 0xff, 0
    s_cselect_b32 s14, 0, 0x31000
    s_cselect_b32 s15, 0, 0x40000000
    s_cselect_b32 s8, 1, 2
    v_mov_b32 v220, s8
    ds_write_b32 v236, v220 offset:4
    s_cmp_eq_u32 s13, 0
    s_cbranch_scc1 L_A_Q0S
    s_mov_b32 s7, 0
L_A_Q0:
    buffer_load_dwordx4 v[60:63], v11, s[40:43], s66 offen sc1
    s_add_u32 s7, s7, 1
L_A_Q0W:
    ds_read_b32 v222, v236
    s_waitcnt lgkmcnt(0)
    v_cmp_eq_u32 vcc, 0, v222
    s_cbranch_vccz L_A_Q0F
    s_getreg_b32 s8, hwreg(HW_REG_IB_STS, 0, 4)
    s_cmp_lg_u32 s8, 0
    s_cbranch_scc1 L_A_Q0W
    s_waitcnt vmcnt(0)
    v_max3_u32 v220, v60, v61, v62
    v_max_u32 v220, v220, v63
    v_cmp_eq_u32 vcc, -1, v220
    s_cbranch_vccz L_A_Q0OK
    s_cmp_lt_u32 s7, 200
    s_cbranch_scc1 L_A_Q0
L_A_Q0S:
    s_mov_b32 s7, 0
FLAG_11:
    buffer_load_dword v239, v6, s[60:63], s11 offen offset:96 sc1
    s_add_u32 s7, s7, 1
    s_cmp_gt_u32 s7, 0x200000
    s_cbranch_scc1 L_END
    s_waitcnt vmcnt(0)
    v_cmp_gt_u32 vcc, 2, v239
    s_cbranch_vccz FLAGD_12
    s_sleep 1
    s_and_b32 s8, s7, 255
    s_or_b32 s8, s8, s13
    s_cbranch_scc1 FLAG_11
    buffer_load_dword v239, v6, s[60:63], 0 offen offset:128 sc1
    s_waitcnt vmcnt(0)
    v_cmp_ne_u32 vcc, 64, v239
    s_cbranch_vccnz FLAG_11
FLAGD_12:
    s_mov_b32 s7, 0
    s_add_u32 s10, s66, s14
POLL_13:
    buffer_load_dwordx4 v[60:63], v11, s[40:43], s10 offen sc1
    s_add_u32 s7, s7, 1
    s_and_b32 s8, s7, s13
    s_cmp_eq_u32 s8, s13
    s_cselect_b32 s8, 0x31000, 0
    s_add_u32 s10, s66, s8
    s_cmp_gt_u32 s7, 0x200000
    s_cbranch_scc1 L_END
    s_waitcnt vmcnt(0)
    v_max3_u32 v220, v60, v61, v62
    v_max_u32 v220, v220, v63
    v_cmp_eq_u32 vcc, -1, v220
    s_cbranch_vccnz POLL_13
L_A_Q0OK:
    ds_write_b128 v237, v[60:63] offset:256
    ds_write_b32 v236, v236
L_A_Q0F:
    s_mov_b32 s7, 0
FLAG_14:
    buffer_load_dword v239, v6, s[60:63], s11 offen offset:96 sc1
    s_add_u32 s7, s7, 1
    s_cmp_gt_u32 s7, 0x200000
    s_cbranch_scc1 L_END
    s_waitcnt vmcnt(0)
    v_cmp_gt_u32 vcc, 1, v239
    s_cbranch_vccz FLAGD_15
    s_sleep 1
    s_and_b32 s8, s7, 255
    s_or_b32 s8, s8, s13
    s_cbranch_scc1 FLAG_14
    buffer_load_dword v239, v6, s[60:63], 0 offen offset:128 sc1
    s_waitcnt vmcnt(0)
    v_cmp_ne_u32 vcc, 64, v239
    s_cbranch_vccnz FLAG_14
FLAGD_15:
L_A_HGO:
    s_setprio 0
L_A_HLOOP:
    s_mov_b32 s7, 0
    s_add_u32 s9, s6, s15
L_A_MW:
    s_sleep 1
    ds_read_b128 v[64:67], v14
    s_add_u32 s7, s7, 1
    s_cmp_gt_u32 s7, 0x800000
    s_cbranch_scc1 L_END
    s_waitcnt lgkmcnt(0)
    v_max3_u32 v220, v64, v65, v66
    v_max_u32 v220, v220, v67
    v_cmp_eq_u32 vcc, -1, v220
    s_cbranch_vccnz L_A_MW
    v_max3_f32 v74, v64, v65, v66
    v_max_f32 v74, v74, v67
    v_sub_f32 v64, v64, v74
    v_sub_f32 v65, v65, v74
    v_sub_f32 v66, v66, v74
    v_sub_f32 v67, v67, v74
    v_exp_f32 v64, v64
    v_exp_f32 v65, v65
    v_exp_f32 v66, v66
    v_exp_f32 v67, v67
    s_barrier
    ds_read_b128 v[32:35], v14 offset:64
    ds_read_b64 v[16:17], v68 offset:0
    ds_read_b64 v[18:19], v68 offset:16384
    ds_read_b64 v[20:21], v68 offset:32768
    ds_read_b64 v[22:23], v68 offset:49152
    s_waitcnt lgkmcnt(4)
    v_pk_mul_f32 v[32:33], v[32:33], v[64:65]
    v_pk_fma_f32 v[32:33], v[34:35], v[66:67], v[32:33]
    v_add_f32 v32, v32, v33
    v_rcp_f32 v33, v32
    v_log_f32 v32, v32
    s_waitcnt lgkmcnt(2)
    v_pk_mul_f32 v[16:17], v[16:17], v[64:65] op_sel:[0,0] op_sel_hi:[1,0]
    v_pk_mul_f32 v[18:19], v[18:19], v[64:65] op_sel:[0,1] op_sel_hi:[1,1]
    s_waitcnt lgkmcnt(0)
    v_pk_fma_f32 v[16:17], v[20:21], v[66:67], v[16:17] op_sel:[0,0,0] op_sel_hi:[1,0,1]
    v_pk_fma_f32 v[18:19], v[22:23], v[66:67], v[18:19] op_sel:[0,1,0] op_sel_hi:[1,1,1]
    v_add_f32 v32, v32, v74
    v_pk_add_f32 v[16:17], v[16:17], v[18:19]
    v_min_u32 v32, -2, v32
    v_pk_mul_f32 v[16:17], v[16:17], v[32:33] op_sel:[0,1] op_sel_hi:[1,1]
    v_cvt_pk_bf16_f32 v16, v16, v17
    v_min_u32 v16, -2, v16
    buffer_store_dword v16, v69, s[40:43], s9 offen
    buffer_store_dword v32, v70, s[40:43], s9 offen
    s_barrier
    v_mov_b32_dpp v17, v16 quad_perm:[1,1,1,1] row_mask:0xf bank_mask:0xf
    v_mov_b32_dpp v18, v16 quad_perm:[2,2,2,2] row_mask:0xf bank_mask:0xf
    v_mov_b32_dpp v19, v16 quad_perm:[3,3,3,3] row_mask:0xf bank_mask:0xf
    s_waitcnt vmcnt(0)
    s_cmp_lg_u32 s6, 0
    s_cbranch_scc1 L_A_GOOK
    s_mov_b32 s7, 0
FLAG_16:
    buffer_load_dword v239, v6, s[60:63], s11 offen offset:96 sc1
    s_add_u32 s7, s7, 1
    s_cmp_gt_u32 s7, 0x200000
    s_cbranch_scc1 L_END
    s_waitcnt vmcnt(0)
    v_cmp_gt_u32 vcc, 2, v239
    s_cbranch_vccz FLAGD_17
    s_sleep 1
    s_and_b32 s8, s7, 255
    s_or_b32 s8, s8, s13
    s_cbranch_scc1 FLAG_16
    buffer_load_dword v239, v6, s[60:63], 0 offen offset:128 sc1
    s_waitcnt vmcnt(0)
    v_cmp_ne_u32 vcc, 64, v239
    s_cbranch_vccnz FLAG_16
FLAGD_17:
L_A_GOOK:
    s_add_u32 s8, s6, 0x31000
    buffer_store_dwordx4 v[16:19], v75, s[40:43], s8 offen sc1
    buffer_store_dword v32, v70, s[40:43], s8 offen sc1
    s_cmp_ge_u32 s5, 6
    s_cbranch_scc1 L_A_NEXT
    s_cmp_lg_u32 s6, 0
    s_cbranch_scc1 L_A_RED1
    buffer_load_dwordx2 v[226:227], v73, s[44:47], s71 offen
    buffer_load_dword v239, v6, s[56:59], s71 offen
    v_and_b32 v220, 40, v1
    v_mov_b32 v221, 0x40000000
    v_cmp_eq_u32 vcc, 0, v220
    s_nop 1
    v_cndmask_b32 v73, v221, v73, vcc
    s_waitcnt vmcnt(0)
    v_lshlrev_b32 v52, 16, v226
    v_and_b32 v53, 0xffff0000, v226
    v_lshlrev_b32 v54, 16, v227
    v_and_b32 v55, 0xffff0000, v227
    s_branch L_A_RED_GO
L_A_RED1:
    s_and_b32 s8, s73, 7
    s_cmp_lg_u32 s8, s3
    s_cbranch_scc1 L_A_NEXT
L_A_RED_GO:
    v_cmp_gt_u32 vcc, 8, v2
    s_nop 1
    v_cndmask_b32 v56, 0, v52, vcc
    v_cndmask_b32 v57, 0, v53, vcc
    v_cndmask_b32 v58, 0, v54, vcc
    v_cndmask_b32 v59, 0, v55, vcc
    s_lshl_b32 s9, s3, 7
    s_add_u32 s9, s9, s6
    s_add_u32 s9, s9, 0x28800
    v_min_u32 v221, 7, v1
    v_lshlrev_b32 v221, 2, v221
    s_mov_b32 s7, 0
L_A_GATE:
    buffer_load_dword v222, v221, s[40:43], s9 offen sc1
    s_add_u32 s7, s7, 1
    s_cmp_gt_u32 s7, s13
    s_cbranch_scc1 L_A_GATED
    s_waitcnt vmcnt(0)
    v_cmp_eq_u32 vcc, -1, v222
    s_cbranch_vccnz L_A_GATE
L_A_GATED:
    s_waitcnt vmcnt(0)
    v_readlane_b32 s74, v222, 7
    s_and_b32 s74, s74, 8192
    s_lshl_b32 s8, s13, 8
    s_and_b32 s74, s74, s8
    s_add_u32 s65, s68, s74
    s_mov_b32 s7, 0
POLL_18:
    buffer_load_dwordx4 v[16:19], v71, s[40:43], s65 offen sc1
    s_add_u32 s7, s7, 1
    s_cmp_gt_u32 s7, 0x200000
    s_cbranch_scc1 L_END
    s_waitcnt vmcnt(0)
    v_mfma_f32_16x16x32_bf16 v[212:215], v[48:51], v[16:19], v[56:59]
    v_max3_u32 v220, v16, v17, v18
    v_max_u32 v220, v220, v19
    v_cmp_eq_u32 vcc, -1, v220
    s_cbranch_vccnz POLL_18
    s_nop 3
    v_add_f32_dpp v220, v212, v212 row_ror:8 row_mask:0xf bank_mask:0xf
    v_add_f32_dpp v221, v213, v213 row_ror:8 row_mask:0xf bank_mask:0xf
    v_add_f32_dpp v222, v214, v214 row_ror:8 row_mask:0xf bank_mask:0xf
    v_add_f32_dpp v223, v215, v215 row_ror:8 row_mask:0xf bank_mask:0xf
    v_cvt_pk_bf16_f32 v224, v220, v221
    v_cvt_pk_bf16_f32 v225, v222, v223
    v_lshlrev_b32 v52, 16, v224
    v_and_b32 v53, 0xffff0000, v224
    v_lshlrev_b32 v54, 16, v225
    v_and_b32 v55, 0xffff0000, v225
    v_cmp_gt_u32 vcc, 8, v2
    s_nop 1
    v_cndmask_b32 v56, 0, v52, vcc
    v_cndmask_b32 v57, 0, v53, vcc
    v_cndmask_b32 v58, 0, v54, vcc
    v_cndmask_b32 v59, 0, v55, vcc
    s_add_u32 s65, s69, s74
    s_add_u32 s70, s65, 0x1000
    s_lshl_b32 s67, s3, 12
    s_add_u32 s67, s67, s71
    s_add_u32 s67, s67, 0x29000
    s_add_u32 s64, s67, s15
    s_mov_b32 s7, 0
POLL_19:
    buffer_load_dwordx4 v[16:19], v72, s[40:43], s65 offen offset:0 sc1
    buffer_load_dwordx4 v[20:23], v72, s[40:43], s65 offen offset:1024 sc1
    buffer_load_dwordx4 v[24:27], v72, s[40:43], s65 offen offset:2048 sc1
    buffer_load_dwordx4 v[28:31], v72, s[40:43], s65 offen offset:3072 sc1
    buffer_load_dwordx4 v[32:35], v72, s[40:43], s70 offen offset:0 sc1
    buffer_load_dwordx4 v[36:39], v72, s[40:43], s70 offen offset:1024 sc1
    buffer_load_dwordx4 v[40:43], v72, s[40:43], s70 offen offset:2048 sc1
    s_add_u32 s7, s7, 1
    s_cmp_gt_u32 s7, 0x200000
    s_cbranch_scc1 L_END
    s_waitcnt vmcnt(6)
    v_mfma_f32_16x16x32_bf16 v[212:215], v[48:51], v[16:19], v[56:59]
    v_max3_u32 v220, v16, v17, v18
    v_max_u32 v220, v220, v19
    s_waitcnt vmcnt(5)
    v_mfma_f32_16x16x32_bf16 v[212:215], v[48:51], v[20:23], v[212:215]
    v_max3_u32 v220, v220, v20, v21
    v_max3_u32 v220, v220, v22, v23
    s_waitcnt vmcnt(4)
    v_mfma_f32_16x16x32_bf16 v[212:215], v[48:51], v[24:27], v[212:215]
    v_max3_u32 v220, v220, v24, v25
    v_max3_u32 v220, v220, v26, v27
    s_waitcnt vmcnt(3)
    v_mfma_f32_16x16x32_bf16 v[212:215], v[48:51], v[28:31], v[212:215]
    v_max3_u32 v220, v220, v28, v29
    v_max3_u32 v220, v220, v30, v31
    s_waitcnt vmcnt(2)
    v_mfma_f32_16x16x32_bf16 v[212:215], v[48:51], v[32:35], v[212:215]
    v_max3_u32 v220, v220, v32, v33
    v_max3_u32 v220, v220, v34, v35
    s_waitcnt vmcnt(1)
    v_mfma_f32_16x16x32_bf16 v[212:215], v[48:51], v[36:39], v[212:215]
    v_max3_u32 v220, v220, v36, v37
    v_max3_u32 v220, v220, v38, v39
    s_waitcnt vmcnt(0)
    v_mfma_f32_16x16x32_bf16 v[212:215], v[48:51], v[40:43], v[212:215]
    v_max3_u32 v220, v220, v40, v41
    v_max3_u32 v220, v220, v42, v43
    v_cmp_eq_u32 vcc, -1, v220
    s_cbranch_vccnz POLL_19
    s_cmp_lg_u32 s6, 0
    s_nop 2
    v_add_f32_dpp v220, v212, v212 row_ror:8 row_mask:0xf bank_mask:0xf
    v_add_f32_dpp v221, v213, v213 row_ror:8 row_mask:0xf bank_mask:0xf
    v_add_f32_dpp v222, v214, v214 row_ror:8 row_mask:0xf bank_mask:0xf
    v_add_f32_dpp v223, v215, v215 row_ror:8 row_mask:0xf bank_mask:0xf
    v_cvt_pk_bf16_f32 v224, v220, v221
    v_cvt_pk_bf16_f32 v225, v222, v223
    s_cbranch_scc1 L_A_OUT
    v_min_u32 v224, -2, v224
    v_min_u32 v225, -2, v225
    buffer_store_dwordx2 v[224:225], v73, s[40:43], s64 offen
    s_add_u32 s67, s67, 0x31000
    s_waitcnt vmcnt(0)
    buffer_store_dwordx2 v[224:225], v73, s[40:43], s67 offen sc1
    v_lshlrev_b32 v52, 16, v224
    v_and_b32 v53, 0xffff0000, v224
    v_lshlrev_b32 v54, 16, v225
    v_and_b32 v55, 0xffff0000, v225
    s_branch L_A_NEXT
L_A_OUT:
    buffer_store_dwordx2 v[224:225], v73, s[56:59], s71 offen
    s_cmp_ge_u32 s73, 8
    s_cbranch_scc1 L_A_NEXT
    buffer_store_dword v6, v6, s[60:63], s11 offen offset:64
    buffer_store_dword v6, v6, s[60:63], s11 offen offset:96
    s_cmp_lg_u32 s73, 0
    s_cbranch_scc1 L_A_NEXT
    buffer_store_dword v6, v6, s[60:63], 0 offen offset:128 sc1
L_A_NEXT:
    s_cmp_lg_u32 s6, 0
    s_cbranch_scc1 L_END
    s_mov_b32 s6, 0xf4000
    s_add_u32 s66, s66, 0xf4000
    s_add_u32 s68, s68, 0xf4000
    s_add_u32 s69, s69, 0xf4000
    v_add_u32 v13, 0x80, v13
    v_add_u32 v14, 0x80, v14
    v_add_u32 v15, 0x80, v15
    s_barrier
    s_cmp_ge_u32 s5, 4
    s_cbranch_scc1 L_A_HLOOP
    s_branch L_A_LOOP
L_B1:
    s_mov_b32 s40, s36
    s_mov_b32 s41, s37
    s_mov_b32 s42, 0x1e8000
    s_mov_b32 s43, 0x20000
    s_mov_b32 s60, s34
    s_mov_b32 s61, s35
    s_mov_b32 s62, 0x100
    s_mov_b32 s63, 0x20000
    v_lshrrev_b32 v157, 2, v1
    v_and_b32 v158, 3, v1
    v_lshlrev_b32 v158, 4, v158
    v_lshl_add_u32 v4, v157, 13, v158
    s_lshl_b32 s9, s5, 19
    s_add_u32 s65, s65, s9
    s_lshl_b32 s9, s64, 6
    s_add_u32 s65, s65, s9
    s_lshl_b32 s9, s5, 12
    s_mov_b32 m0, s9
    v_mov_b32 v160, -1
    v_mov_b32 v161, -1
    v_mov_b32 v162, -1
    v_mov_b32 v163, -1
    s_lshl_b32 s11, s3, 2
    v_mov_b32 v5, 0
    v_mov_b32 v178, 1
    s_lshl_b32 s8, s64, 3
    s_add_u32 s8, s8, s3
    s_lshl_b32 s8, s8, 13
    s_lshl_b32 s9, s5, 10
    s_add_u32 s8, s8, s9
    s_add_u32 s8, s8, 0x31000
    s_cmp_ge_u32 s8, 0x74000
    s_cselect_b32 s9, 0xb1000, 0
    s_add_u32 s8, s8, s9
    s_cmp_ge_u32 s8, 0x156000
    s_cselect_b32 s8, 0x40000000, s8
    buffer_store_dwordx4 v[160:163], v156, s[40:43], s8 offen sc1
    s_mov_b32 s44, s16
    s_mov_b32 s45, s17
    s_mov_b32 s46, 0x1000
    s_mov_b32 s47, 0x20000
    v_lshrrev_b32 v159, 2, v2
    v_lshrrev_b32 v164, 1, v3
    v_and_b32 v165, 1, v3
    v_lshl_add_u32 v14, v164, 6, v158
    v_lshl_add_u32 v14, v165, 3, v14
    v_lshl_add_u32 v14, v159, 10, v14
    s_lshl_b32 s68, s5, 7
    buffer_load_dwordx2 v[172:173], v14, s[44:47], s68 offen
    s_mov_b32 s6, 0
    s_mov_b32 s38, 0x05040100
    s_mov_b32 s39, 0x07060302
    s_mov_b32 s52, s24
    s_mov_b32 s53, s25
    s_mov_b32 s54, 0x400000
    s_mov_b32 s55, 0x20000
    v_lshrrev_b32 v7, 1, v158
    v_lshl_add_u32 v8, v159, 7, v7
    v_lshl_add_u32 v8, v3, 10, v8
    v_lshl_add_u32 v7, v159, 6, v7
    v_lshl_add_u32 v7, v165, 9, v7
    v_lshl_add_u32 v7, v164, 8, v7
    s_lshl_b32 s8, s5, 12
    v_add_u32 v7, s8, v7
    s_lshl_b32 s8, s5, 9
    s_add_u32 s8, s8, 0x18000
    v_and_b32 v160, 7, v2
    v_lshlrev_b32 v9, 2, v160
    v_lshl_add_u32 v9, v3, 5, v9
    v_lshrrev_b32 v160, 3, v2
    v_lshl_add_u32 v9, v160, 7, v9
    v_add_u32 v9, s8, v9
    v_lshlrev_b32 v11, 3, v1
    v_add_u32 v161, 0x1a100, v11
    v_add_u32 v11, 0x18000, v11
    v_lshlrev_b32 v12, 6, v159
    v_add_u32 v12, 0x1a000, v12
    s_lshl_b32 s8, s5, 3
    v_add_u32 v160, s8, v12
    v_and_b32 v163, 2, v2
    v_lshl_add_u32 v160, v163, 1, v160
    v_lshlrev_b32 v162, 2, v3
    v_and_b32 v163, 13, v2
    v_cmp_eq_u32 vcc, v162, v163
    s_nop 1
    v_cndmask_b32 v10, v161, v160, vcc
    v_add_u32 v12, v12, v158
    v_lshrrev_b32 v13, 2, v158
    v_lshl_add_u32 v13, v3, 4, v13
    v_lshl_add_u32 v13, v159, 10, v13
    s_lshl_b32 s67, s3, 12
    s_lshl_b32 s8, s64, 6
    s_add_u32 s67, s67, s8
    s_add_u32 s67, s67, 0x0
    v_mov_b32 v16, 0x40000000
    v_mov_b32 v107, 0x40000000
    v_mov_b32 v15, 0
    v_and_b32 v160, 3, v1
    v_mov_b32 v161, 0x40000000
    v_cmp_eq_u32 vcc, 0, v160
    s_nop 1
    v_cndmask_b32 v6, v161, v13, vcc
    v_and_b32 v225, 1, v1
    v_mul_u32_u24 v225, 0xaaaa, v225
    v_add_u32 v225, 0x4444, v225
    v_mov_b32 v132, 0
    v_mov_b32 v133, 0
    v_mov_b32 v134, 0
    v_mov_b32 v135, 0
    v_mov_b32 v124, 0x3f803f80
    v_mov_b32 v125, 0x3f803f80
    v_mov_b32 v126, 0x3f803f80
    v_mov_b32 v127, 0x3f803f80
    s_cmp_lg_u32 s70, 7
    s_cbranch_scc1 L_B_NOF1
    s_getreg_b32 s8, hwreg(HW_REG_XCC_ID, 0, 4)
    s_add_u32 s8, s8, 1
    v_mov_b32 v166, s8
    v_lshlrev_b32 v167, 10, v1
    s_waitcnt vmcnt(0)
    buffer_store_dword v166, v167, s[60:63], s11 offen offset:64
L_B_NOF1:
    s_waitcnt vmcnt(2)
    buffer_load_dword v19, v5, s[60:63], s11 offen offset:64 sc1
    buffer_load_dwordx4 v4, s[48:51], s65 offen offset:0  lds
    s_add_u32 s65, s65, 130048
    buffer_load_dwordx4 v4, s[48:51], s65 offen offset:1024  lds
    s_add_u32 s65, s65, 130048
    buffer_load_dwordx4 v4, s[48:51], s65 offen offset:2048  lds
    s_add_u32 s65, s65, 130048
    buffer_load_dwordx4 v4, s[48:51], s65 offen offset:3072  lds
    s_waitcnt vmcnt(4)
    s_mov_b32 s7, 0
L_B_FL0:
    v_cmp_gt_u32 vcc, 1, v19
    s_cbranch_vccz L_B_FL1
    buffer_load_dword v19, v5, s[60:63], s11 offen offset:64 sc1
    s_add_u32 s7, s7, 1
    s_waitcnt vmcnt(0)
    s_cmp_lt_u32 s7, 32
    s_cbranch_scc1 L_B_FL0
L_B_FL1:
    s_cmp_ge_u32 s64, 8
    s_cbranch_scc1 L_B_FL2
    s_waitcnt vmcnt(0)
L_B_FL2:
    s_barrier
    s_cmp_ge_u32 s64, 8
    s_cbranch_scc1 L_B_WPF
    s_waitcnt vmcnt(0)
    s_branch L_B_VPD
L_B_WPF:
    s_lshl_b32 s8, s3, 19
    s_lshl_b32 s9, s64, 16
    s_add_u32 s8, s8, s9
    s_lshl_b32 s9, s5, 12
    s_add_u32 s8, s8, s9
    s_sub_u32 s8, s8, 0x80000
    s_add_u32 s9, s8, 0x8000
    v_lshlrev_b32 v156, 4, v1
    buffer_load_dwordx4 v[84:87], v156, s[52:55], s8 offen offset:0
    buffer_load_dwordx4 v[88:91], v156, s[52:55], s8 offen offset:1024
    buffer_load_dwordx4 v[92:95], v156, s[52:55], s8 offen offset:2048
    buffer_load_dwordx4 v[96:99], v156, s[52:55], s8 offen offset:3072
    s_waitcnt vmcnt(4)
L_B_VPD:
    s_sub_u32 s9, s70, 16
    s_cmp_ge_u32 s9, 8
    s_cbranch_scc1 L_B_NOCNT
    s_mov_b64 exec, 1
    buffer_atomic_add v178, v5, s[60:63], 0 offen offset:128
    s_mov_b64 exec, -1
L_B_NOCNT:
    ds_read_b64_tr_b16 v[20:21], v7 offset:0
    ds_read_b64_tr_b16 v[22:23], v7 offset:32
    ds_read_b64_tr_b16 v[24:25], v7 offset:2048
    ds_read_b64_tr_b16 v[26:27], v7 offset:2080
    ds_read_b64_tr_b16 v[28:29], v7 offset:1024
    ds_read_b64_tr_b16 v[30:31], v7 offset:1056
    ds_read_b64_tr_b16 v[32:33], v7 offset:3072
    ds_read_b64_tr_b16 v[34:35], v7 offset:3104
    v_cmp_gt_u32 vcc, 1, v19
    s_cbranch_vccz FOK_20
    s_mov_b32 s7, 0
FLAG_21:
    buffer_load_dword v19, v5, s[60:63], s11 offen offset:64 sc1
    s_add_u32 s7, s7, 1
    s_cmp_gt_u32 s7, 0x200000
    s_cbranch_scc1 L_END
    s_waitcnt vmcnt(0)
    v_cmp_gt_u32 vcc, 1, v19
    s_cbranch_vccz FLAGD_22
    s_sleep 1
    s_and_b32 s8, s7, 255
    s_cbranch_scc1 FLAG_21
    buffer_load_dword v19, v5, s[60:63], 0 offen offset:128 sc1
    s_waitcnt vmcnt(0)
    v_cmp_ne_u32 vcc, 64, v19
    s_cbranch_vccnz FLAG_21
FLAGD_22:
FOK_20:
    v_readfirstlane_b32 s8, v19
    s_getreg_b32 s9, hwreg(HW_REG_XCC_ID, 0, 4)
    s_add_u32 s9, s9, 1
    s_cmp_eq_u32 s8, s9
    s_cselect_b32 s13, 0xff, 0
    s_cselect_b32 s14, 0, 0x31000
    s_cselect_b32 s15, 0, 0x40000000
    v_mov_b32 v128, 0
    v_mov_b32 v129, 0
    v_mov_b32 v130, 0
    v_mov_b32 v131, 0
    s_waitcnt lgkmcnt(0)
    v_swap_b32 v21, v22
    v_swap_b32 v25, v26
    v_swap_b32 v29, v30
    v_swap_b32 v33, v34
    v_smfmac_f32_16x16x64_bf16 v[128:131], v[124:127], v[20:27], v225
    s_nop 0
    v_smfmac_f32_16x16x64_bf16 v[128:131], v[124:127], v[28:35], v225
    s_nop 7
    ds_write_b32 v9, v128 offset:9216
    ds_write_b32 v9, v129 offset:9472
    s_branch L_B_QGO
L_B_QCS:
    ds_read_b64 v[180:181], v11 offset:9216
    ds_read_b64 v[182:183], v11 offset:9728
    ds_read_b64 v[184:185], v11 offset:10240
    ds_read_b64 v[186:187], v11 offset:10752
    ds_read_b64 v[188:189], v11 offset:11264
    ds_read_b64 v[190:191], v11 offset:11776
    ds_read_b64 v[192:193], v11 offset:12288
    ds_read_b64 v[194:195], v11 offset:12800
    s_waitcnt lgkmcnt(0)
    v_pk_add_f32 v[180:181], v[180:181], v[182:183]
    v_pk_add_f32 v[184:185], v[184:185], v[186:187]
    v_pk_add_f32 v[188:189], v[188:189], v[190:191]
    v_pk_add_f32 v[192:193], v[192:193], v[194:195]
    v_pk_add_f32 v[180:181], v[180:181], v[184:185]
    v_pk_add_f32 v[188:189], v[188:189], v[192:193]
    v_pk_add_f32 v[174:175], v[180:181], v[188:189]
    s_branch L_B_QFIN
L_B_LOOP:
    v_mov_b32 v132, 0
    v_mov_b32 v133, 0
    v_mov_b32 v134, 0
    v_mov_b32 v135, 0
    s_mov_b32 s7, 0
    s_add_u32 s10, s68, s14
POLL_23:
    buffer_load_dwordx2 v[172:173], v14, s[40:43], s10 offen sc1
    s_add_u32 s7, s7, 1
    s_and_b32 s8, s7, s13
    s_cmp_eq_u32 s8, s13
    s_cselect_b32 s8, 0x31000, 0
    s_add_u32 s10, s68, s8
    s_cmp_gt_u32 s7, 0x200000
    s_cbranch_scc1 L_END
    s_waitcnt vmcnt(0)
    v_max_u32 v156, v172, v173
    v_cmp_eq_u32 vcc, -1, v156
    s_cbranch_vccnz POLL_23
L_B_QGO:
    s_mov_b32 vcc_lo, 0x44444444
    s_mov_b32 vcc_hi, 0x44444444
    v_cndmask_b32_dpp v116, v172, v124, vcc quad_perm:[0,0,0,0] row_mask:0xf bank_mask:0xf
    v_cndmask_b32_dpp v117, v173, v124, vcc quad_perm:[0,0,0,0] row_mask:0xf bank_mask:0xf
    v_cndmask_b32_dpp v118, v172, v124, vcc quad_perm:[1,1,1,1] row_mask:0xf bank_mask:0xf
    v_cndmask_b32_dpp v119, v173, v124, vcc quad_perm:[1,1,1,1] row_mask:0xf bank_mask:0xf
    v_cndmask_b32_dpp v120, v172, v124, vcc quad_perm:[2,2,2,2] row_mask:0xf bank_mask:0xf
    v_cndmask_b32_dpp v121, v173, v124, vcc quad_perm:[2,2,2,2] row_mask:0xf bank_mask:0xf
    v_mfma_f32_16x16x32_bf16 v[136:139], v[116:119], v[116:119], 0
    v_cndmask_b32_dpp v122, v172, v124, vcc quad_perm:[3,3,3,3] row_mask:0xf bank_mask:0xf
    v_cndmask_b32_dpp v123, v173, v124, vcc quad_perm:[3,3,3,3] row_mask:0xf bank_mask:0xf
    v_smfmac_f32_16x16x64_bf16 v[132:135], v[116:119], v[20:27], v225
    s_nop 0
    v_mfma_f32_16x16x32_bf16 v[136:139], v[120:123], v[120:123], v[136:139]
    v_smfmac_f32_16x16x64_bf16 v[132:135], v[120:123], v[28:35], v225
    s_nop 6
    ds_write_b32 v10, v136
    ds_write2_b32 v9, v132, v133 offset0:0 offset1:64
    s_waitcnt lgkmcnt(0)
    s_barrier
    s_cmp_lg_u32 s5, 0
    s_cbranch_scc1 L_B_QDONE
    s_cmp_eq_u32 s6, 0
    s_cbranch_scc1 L_B_QCS
L_B_QFIN:
    s_add_u32 s9, s67, s15
    ds_read_b128 v[196:199], v12
    ds_read_b64 v[180:181], v11 offset:0
    ds_read_b64 v[182:183], v11 offset:512
    ds_read_b64 v[184:185], v11 offset:1024
    ds_read_b64 v[186:187], v11 offset:1536
    ds_read_b64 v[188:189], v11 offset:2048
    ds_read_b64 v[190:191], v11 offset:2560
    ds_read_b64 v[192:193], v11 offset:3072
    ds_read_b64 v[194:195], v11 offset:3584
    s_waitcnt lgkmcnt(8)
    v_pk_add_f32 v[164:165], v[196:197], v[198:199]
    s_nop 1
    v_add_f32_dpp v165, v165, v165 quad_perm:[1,0,3,2] row_mask:0xf bank_mask:0xf
    v_add_f32_dpp v164, v164, v164 quad_perm:[1,0,3,2] row_mask:0xf bank_mask:0xf
    s_nop 0
    v_add_f32_dpp v165, v165, v165 quad_perm:[2,3,0,1] row_mask:0xf bank_mask:0xf
    v_add_f32_dpp v164, v164, v164 quad_perm:[2,3,0,1] row_mask:0xf bank_mask:0xf
    v_mul_f32 v165, 0x3b000000, v165
    v_mul_f32 v164, 0x3b000000, v164
    s_waitcnt lgkmcnt(4)
    v_pk_add_f32 v[180:181], v[180:181], v[182:183]
    v_fma_f32 v164, -v165, v165, v164
    v_pk_add_f32 v[184:185], v[184:185], v[186:187]
    v_max_f32 v164, 0, v164
    v_pk_add_f32 v[180:181], v[180:181], v[184:185]
    v_add_f32 v164, 0x3727c5ac, v164
    v_fma_f32 v180, -v165, v174, v180
    v_rsq_f32 v164, v164
    v_fma_f32 v181, -v165, v175, v181
    s_waitcnt lgkmcnt(0)
    v_pk_add_f32 v[188:189], v[188:189], v[190:191]
    v_pk_add_f32 v[192:193], v[192:193], v[194:195]
    v_pk_add_f32 v[180:181], v[180:181], v[188:189]
    v_pk_add_f32 v[160:161], v[180:181], v[192:193]
    v_pk_mul_f32 v[160:161], v[160:161], v[164:165] op_sel:[0,0] op_sel_hi:[1,0]
    v_cvt_pk_bf16_f32 v212, v160, v161
    v_min_u32 v212, -2, v212
    buffer_store_dword v212, v13, s[40:43], s9 offen
    s_nop 0
    v_mov_b32_dpp v213, v212 quad_perm:[1,1,1,1] row_mask:0xf bank_mask:0xf
    v_mov_b32_dpp v214, v212 quad_perm:[2,2,2,2] row_mask:0xf bank_mask:0xf
    v_mov_b32_dpp v215, v212 quad_perm:[3,3,3,3] row_mask:0xf bank_mask:0xf
L_B_QDONE:
    s_barrier
    s_or_b32 s8, s64, s6
    s_cmp_lg_u32 s8, 7
    s_cbranch_scc1 L_B_QBD
    v_mov_b32 v100, -1
    v_mov_b32 v101, -1
    v_mov_b32 v102, -1
    v_mov_b32 v103, -1
    v_lshlrev_b32 v104, 4, v0
    v_lshlrev_b32 v105, 3, v0
    s_lshl_b32 s8, s3, 14
    s_add_u32 s8, s8, 0x8000
    s_add_u32 s9, s8, 0x2000
    buffer_store_dwordx4 v[100:103], v104, s[40:43], s8 offen
    buffer_store_dwordx4 v[100:103], v104, s[40:43], s9 offen
    s_add_u32 s8, s8, 0xf4000
    s_add_u32 s9, s9, 0xf4000
    buffer_store_dwordx4 v[100:103], v104, s[40:43], s8 offen
    buffer_store_dwordx4 v[100:103], v104, s[40:43], s9 offen
    s_lshl_b32 s8, s3, 12
    s_add_u32 s9, s8, 0x29000
    s_add_u32 s8, s8, 0xf4000
    buffer_store_dwordx2 v[100:101], v105, s[40:43], s8 offen
    buffer_store_dwordx2 v[100:101], v105, s[40:43], s9 offen
    s_lshl_b32 s8, s3, 8
    s_and_b32 s9, s5, 1
    s_mul_i32 s9, s9, 0xf4000
    s_add_u32 s8, s8, s9
    s_add_u32 s8, s8, 0x28000
    v_lshlrev_b32 v104, 2, v1
    buffer_store_dword v100, v104, s[40:43], s8 offen
    s_lshl_b32 s8, s3, 7
    s_add_u32 s8, s8, s9
    s_add_u32 s8, s8, 0x28800
    v_lshlrev_b32 v104, 1, v1
    buffer_store_short v100, v104, s[40:43], s8 offen
    s_cmp_lg_u32 s5, 0
    s_cbranch_scc1 L_B_SP1
    buffer_load_dword v19, v5, s[60:63], 0 offen offset:128 sc1
L_B_SP1:
    s_waitcnt vmcnt(0)
    s_barrier
    s_lshl_b32 s8, s3, 14
    s_add_u32 s8, s8, 0x8000
    s_lshl_b32 s9, s3, 8
    s_add_u32 s9, s9, 0x28000
    s_cmp_lg_u32 s5, 0
    s_cbranch_scc1 L_B_PROBE
    v_lshlrev_b32 v157, 10, v1
    v_cmp_ne_u32 vcc, 64, v19
    s_cbranch_vccz L_B_GO
    buffer_store_dword v178, v157, s[60:63], s11 offen offset:96
    s_mov_b32 s7, 0
L_B_RELAY:
    buffer_load_dword v19, v5, s[60:63], 0 offen offset:128 sc1
    s_add_u32 s7, s7, 1
    s_cmp_gt_u32 s7, 0x200000
    s_cbranch_scc1 L_END
    s_waitcnt vmcnt(0)
    v_cmp_ne_u32 vcc, 64, v19
    s_cbranch_vccnz L_B_RELAY
L_B_GO:
    buffer_store_dword v19, v157, s[60:63], s11 offen offset:96
    v_lshlrev_b32 v157, 7, v1
    v_lshlrev_b32 v104, 2, v1
    buffer_load_dword v106, v157, s[40:43], s8 offen sc1
    s_add_u32 s8, s8, 0x2000
    buffer_load_dword v106, v157, s[40:43], s8 offen sc1
    buffer_load_dword v107, v104, s[40:43], s9 offen sc1
    s_branch L_B_SPARE
L_B_QBD:
    s_cmp_ge_u32 s64, 8
    s_cbranch_scc1 L_B_O
    s_cmp_lg_u32 s6, 0
    s_cbranch_scc1 L_B_F1
    s_mov_b32 s52, s28
    s_mov_b32 s53, s29
    s_mov_b32 s54, 0x1c0000
    s_mov_b32 s55, 0x20000
    s_mov_b32 s56, s30
    s_mov_b32 s57, s31
    s_mov_b32 s58, 0x1c0000
    s_mov_b32 s59, 0x20000
    s_mul_i32 s8, s3, 448
    s_and_b32 s8, s8, 0xffffff80
    s_lshl_b32 s9, s64, 3
    s_add_u32 s9, s9, s5
    s_mul_i32 s9, s9, 35840
    s_add_u32 s8, s8, s9
    v_lshrrev_b32 v156, 5, v1
    v_mul_u32_u24 v156, 3584, v156
    v_and_b32 v157, 31, v1
    v_lshl_add_u32 v156, v157, 4, v156
    buffer_load_dwordx4 v[96:99], v156, s[52:55], s8 offen
    s_add_u32 s8, s8, 7168
    buffer_load_dwordx4 v[100:103], v156, s[52:55], s8 offen
    s_add_u32 s8, s8, 7168
    buffer_load_dwordx4 v[104:107], v156, s[52:55], s8 offen
    s_add_u32 s8, s8, 7168
    buffer_load_dwordx4 v[108:111], v156, s[52:55], s8 offen
    s_add_u32 s8, s8, 7168
    buffer_load_dwordx4 v[112:115], v156, s[52:55], s8 offen
    s_mul_i32 s72, s3, 7
    s_add_u32 s72, s72, s64
    s_mul_i32 s65, s5, 229376
    s_lshl_b32 s9, s72, 6
    s_add_u32 s65, s65, s9
    s_lshl_b32 s66, s72, 15
    s_lshl_b32 s9, s5, 8
    s_add_u32 s66, s66, s9
    s_lshl_b32 s9, s5, 12
    s_add_u32 s9, s9, 0x8000
    s_mov_b32 m0, s9
    v_lshrrev_b32 v156, 2, v1
    v_mul_u32_u24 v156, 3584, v156
    v_and_b32 v157, 3, v1
    v_lshl_add_u32 v156, v157, 4, v156
    v_lshlrev_b32 v157, 4, v2
    v_lshl_add_u32 v157, v3, 12, v157
    v_lshrrev_b32 v164, 2, v2
    v_and_b32 v165, 3, v2
    v_lshlrev_b32 v15, 4, v1
    s_and_b32 s71, s5, 6
    s_lshl_b32 s71, s71, 13
    s_and_b32 s8, s5, 1
    s_lshl_b32 s8, s8, 12
    s_add_u32 s71, s71, s8
    s_add_u32 s71, s71, 0x64000
    v_lshrrev_b32 v164, 3, v2
    v_lshl_add_u32 v164, v3, 3, v164
    v_lshlrev_b32 v16, 14, v164
    v_and_b32 v164, 7, v2
    v_lshl_add_u32 v16, v164, 4, v16
    s_lshl_b32 s72, s72, 7
    s_lshl_b32 s8, s5, 15
    s_add_u32 s72, s72, s8
    s_add_u32 s72, s72, 0x74000
    s_lshl_b32 s8, s3, 7
    s_add_u32 s8, s8, 0x2881c
    v_min_u32 v8, 8, v1
    v_lshl_add_u32 v8, v8, 2, s8
    v_xor_b32 v164, 8, v2
    v_and_b32 v166, 1, v2
    v_lshlrev_b32 v166, 4, v166
    v_mov_b32 v167, 0x3f80
    v_lshlrev_b32 v166, v166, v167
    v_lshrrev_b32 v167, 1, v2
    v_cmp_eq_u32 vcc, 0, v167
    s_nop 1
    v_cndmask_b32 v144, 0, v166, vcc
    v_cmp_eq_u32 vcc, 1, v167
    s_nop 1
    v_cndmask_b32 v145, 0, v166, vcc
    v_cmp_eq_u32 vcc, 2, v167
    s_nop 1
    v_cndmask_b32 v146, 0, v166, vcc
    v_cmp_eq_u32 vcc, 3, v167
    s_nop 1
    v_cndmask_b32 v147, 0, v166, vcc
    v_and_b32 v166, 1, v164
    v_lshlrev_b32 v166, 4, v166
    v_mov_b32 v167, 0x3f80
    v_lshlrev_b32 v166, v166, v167
    v_lshrrev_b32 v167, 1, v164
    v_cmp_eq_u32 vcc, 0, v167
    s_nop 1
    v_cndmask_b32 v148, 0, v166, vcc
    v_cmp_eq_u32 vcc, 1, v167
    s_nop 1
    v_cndmask_b32 v149, 0, v166, vcc
    v_cmp_eq_u32 vcc, 2, v167
    s_nop 1
    v_cndmask_b32 v150, 0, v166, vcc
    v_cmp_eq_u32 vcc, 3, v167
    s_nop 1
    v_cndmask_b32 v151, 0, v166, vcc
    s_waitcnt vmcnt(0)
    buffer_load_dwordx4 v156, s[52:55], s65 offen offset:0  lds
    s_add_u32 s65, s65, 56320
    buffer_load_dwordx4 v156, s[52:55], s65 offen offset:1024  lds
    s_add_u32 s65, s65, 56320
    buffer_load_dwordx4 v156, s[52:55], s65 offen offset:2048  lds
    s_add_u32 s65, s65, 56320
    buffer_load_dwordx4 v156, s[52:55], s65 offen offset:3072  lds
    s_barrier
    s_cmp_ge_u32 s5, 4
    s_cbranch_scc1 L_B_NOW2
    s_add_u32 s9, s66, 0x4000
    buffer_load_dwordx4 v[52:55], v157, s[56:59], s66 offen offset:0
    buffer_load_dwordx4 v[56:59], v157, s[56:59], s66 offen offset:1024
    buffer_load_dwordx4 v[60:63], v157, s[56:59], s66 offen offset:2048
    buffer_load_dwordx4 v[64:67], v157, s[56:59], s66 offen offset:3072
    buffer_load_dwordx4 v[68:71], v157, s[56:59], s9 offen offset:0
    buffer_load_dwordx4 v[72:75], v157, s[56:59], s9 offen offset:1024
    buffer_load_dwordx4 v[76:79], v157, s[56:59], s9 offen offset:2048
    buffer_load_dwordx4 v[80:83], v157, s[56:59], s9 offen offset:3072
    s_waitcnt vmcnt(8)
    s_branch L_B_W1D
L_B_NOW2:
    s_waitcnt vmcnt(0)
L_B_W1D:
    ds_read_b64_tr_b16 v[36:37], v7 offset:32768
    ds_read_b64_tr_b16 v[38:39], v7 offset:32800
    ds_read_b64_tr_b16 v[40:41], v7 offset:34816
    ds_read_b64_tr_b16 v[42:43], v7 offset:34848
    ds_read_b64_tr_b16 v[44:45], v7 offset:33792
    ds_read_b64_tr_b16 v[46:47], v7 offset:33824
    ds_read_b64_tr_b16 v[48:49], v7 offset:35840
    ds_read_b64_tr_b16 v[50:51], v7 offset:35872
    v_mov_b32 v128, 0
    v_mov_b32 v129, 0
    v_mov_b32 v130, 0
    v_mov_b32 v131, 0
    s_waitcnt lgkmcnt(0)
    v_swap_b32 v37, v38
    v_swap_b32 v41, v42
    v_swap_b32 v45, v46
    v_swap_b32 v49, v50
    v_smfmac_f32_16x16x64_bf16 v[128:131], v[124:127], v[36:43], v225
    s_nop 0
    v_smfmac_f32_16x16x64_bf16 v[128:131], v[124:127], v[44:51], v225
    s_nop 7
    ds_write_b32 v9, v128 offset:9216
    ds_write_b32 v9, v129 offset:9472
    s_waitcnt lgkmcnt(0)
    s_barrier
    ds_read_b64 v[180:181], v11 offset:9216
    ds_read_b64 v[182:183], v11 offset:9728
    ds_read_b64 v[184:185], v11 offset:10240
    ds_read_b64 v[186:187], v11 offset:10752
    ds_read_b64 v[188:189], v11 offset:11264
    ds_read_b64 v[190:191], v11 offset:11776
    ds_read_b64 v[192:193], v11 offset:12288
    ds_read_b64 v[194:195], v11 offset:12800
    s_waitcnt lgkmcnt(0)
    v_pk_add_f32 v[180:181], v[180:181], v[182:183]
    v_pk_add_f32 v[184:185], v[184:185], v[186:187]
    v_pk_add_f32 v[188:189], v[188:189], v[190:191]
    v_pk_add_f32 v[192:193], v[192:193], v[194:195]
    v_pk_add_f32 v[180:181], v[180:181], v[184:185]
    v_pk_add_f32 v[188:189], v[188:189], v[192:193]
    v_pk_add_f32 v[176:177], v[180:181], v[188:189]
    s_mov_b32 s7, 0
FLAG_24:
    buffer_load_dword v19, v5, s[60:63], s11 offen offset:96 sc1
    s_add_u32 s7, s7, 1
    s_cmp_gt_u32 s7, 0x200000
    s_cbranch_scc1 L_END
    s_waitcnt vmcnt(0)
    v_cmp_gt_u32 vcc, 2, v19
    s_cbranch_vccz FLAGD_25
    s_sleep 1
    s_and_b32 s8, s7, 255
    s_or_b32 s8, s8, s13
    s_cbranch_scc1 FLAG_24
    buffer_load_dword v19, v5, s[60:63], 0 offen offset:128 sc1
    s_waitcnt vmcnt(0)
    v_cmp_ne_u32 vcc, 64, v19
    s_cbranch_vccnz FLAG_24
FLAGD_25:
    v_perm_b32 v84, v56, v52, s38
    v_perm_b32 v85, v56, v52, s39
    v_perm_b32 v92, v57, v53, s38
    v_perm_b32 v93, v57, v53, s39
    v_perm_b32 v100, v58, v54, s38
    v_perm_b32 v101, v58, v54, s39
    v_perm_b32 v108, v59, v55, s38
    v_perm_b32 v109, v59, v55, s39
    v_perm_b32 v86, v64, v60, s38
    v_perm_b32 v87, v64, v60, s39
    v_perm_b32 v94, v65, v61, s38
    v_perm_b32 v95, v65, v61, s39
    v_perm_b32 v102, v66, v62, s38
    v_perm_b32 v103, v66, v62, s39
    v_perm_b32 v110, v67, v63, s38
    v_perm_b32 v111, v67, v63, s39
    v_perm_b32 v88, v72, v68, s38
    v_perm_b32 v89, v72, v68, s39
    v_perm_b32 v96, v73, v69, s38
    v_perm_b32 v97, v73, v69, s39
    v_perm_b32 v104, v74, v70, s38
    v_perm_b32 v105, v74, v70, s39
    v_perm_b32 v112, v75, v71, s38
    v_perm_b32 v113, v75, v71, s39
    v_perm_b32 v90, v80, v76, s38
    v_perm_b32 v91, v80, v76, s39
    v_perm_b32 v98, v81, v77, s38
    v_perm_b32 v99, v81, v77, s39
    v_perm_b32 v106, v82, v78, s38
    v_perm_b32 v107, v82, v78, s39
    v_perm_b32 v114, v83, v79, s38
    v_perm_b32 v115, v83, v79, s39
    s_branch L_B_F
L_B_F1:
    s_cmp_lg_u32 s64, 7
    s_cbranch_scc1 L_B_F
    s_branch L_B_SPARE3
L_B_F:
    v_lshlrev_b32 v152, 16, v172
    v_and_b32 v153, 0xffff0000, v172
    v_lshlrev_b32 v154, 16, v173
    v_and_b32 v155, 0xffff0000, v173
    v_mov_b32 v132, 0
    v_mov_b32 v133, 0
    v_mov_b32 v134, 0
    v_mov_b32 v135, 0
    v_mov_b32 v68, 0
    v_mov_b32 v69, 0
    v_mov_b32 v70, 0
    v_mov_b32 v71, 0
    v_mov_b32 v72, 0
    v_mov_b32 v73, 0
    v_mov_b32 v74, 0
    v_mov_b32 v75, 0
    v_mov_b32 v76, 0
    v_mov_b32 v77, 0
    v_mov_b32 v78, 0
    v_mov_b32 v79, 0
    v_mov_b32 v80, 0
    v_mov_b32 v81, 0
    v_mov_b32 v82, 0
    v_mov_b32 v83, 0
    s_cmp_lg_u32 s5, 0
    s_cbranch_scc1 QB_26
    s_add_u32 s8, s67, 0x31000
    buffer_store_dwordx4 v[212:215], v6, s[40:43], s8 offen sc1
QB_26:
    s_add_u32 s66, s72, 0x2000
    s_mov_b32 s7, 0
L_B_GATE:
    buffer_load_dword v158, v8, s[40:43], s6 offen sc1
    s_add_u32 s7, s7, 1
    s_cmp_gt_u32 s7, s13
    s_cbranch_scc1 L_B_GATED
    s_waitcnt vmcnt(0)
    v_cmp_eq_u32 vcc, -1, v158
    s_cbranch_vccnz L_B_GATE
L_B_GATED:
    s_waitcnt vmcnt(0)
    v_readfirstlane_b32 s74, v158
    s_and_b32 s74, s74, 8192
    s_lshl_b32 s8, s13, 8
    s_and_b32 s74, s74, s8
    s_add_u32 s69, s71, s74
    s_mov_b32 s7, 0
POLL_27:
    buffer_load_dwordx4 v[52:55], v15, s[40:43], s69 offen offset:0 sc1
    buffer_load_dwordx4 v[56:59], v15, s[40:43], s69 offen offset:2048 sc1
    buffer_load_dwordx4 v[60:63], v15, s[40:43], s69 offen offset:1024 sc1
    buffer_load_dwordx4 v[64:67], v15, s[40:43], s69 offen offset:3072 sc1
    s_add_u32 s7, s7, 1
    s_cmp_gt_u32 s7, 0x200000
    s_cbranch_scc1 L_END
    s_waitcnt vmcnt(3)
    v_mfma_f32_16x16x32_bf16 v[128:131], v[144:147], v[52:55], v[152:155]
    v_max3_u32 v156, v52, v53, v54
    v_max_u32 v156, v156, v55
    s_waitcnt vmcnt(2)
    v_mfma_f32_16x16x32_bf16 v[128:131], v[144:147], v[56:59], v[128:131]
    v_max3_u32 v156, v156, v56, v57
    v_max3_u32 v156, v156, v58, v59
    s_waitcnt vmcnt(1)
    v_mfma_f32_16x16x32_bf16 v[128:131], v[148:151], v[60:63], v[128:131]
    v_max3_u32 v156, v156, v60, v61
    v_max3_u32 v156, v156, v62, v63
    s_waitcnt vmcnt(0)
    v_mfma_f32_16x16x32_bf16 v[128:131], v[148:151], v[64:67], v[128:131]
    v_max3_u32 v156, v156, v64, v65
    v_max3_u32 v156, v156, v66, v67
    v_cmp_eq_u32 vcc, -1, v156
    s_cbranch_vccnz POLL_27
    s_nop 3
    v_cvt_pk_bf16_f32 v156, v128, v129
    v_cvt_pk_bf16_f32 v157, v130, v131
    s_mov_b32 vcc_lo, 0x44444444
    s_mov_b32 vcc_hi, 0x44444444
    v_cndmask_b32_dpp v116, v156, v124, vcc quad_perm:[0,0,0,0] row_mask:0xf bank_mask:0xf
    v_cndmask_b32_dpp v117, v157, v124, vcc quad_perm:[0,0,0,0] row_mask:0xf bank_mask:0xf
    v_cndmask_b32_dpp v118, v156, v124, vcc quad_perm:[1,1,1,1] row_mask:0xf bank_mask:0xf
    v_cndmask_b32_dpp v119, v157, v124, vcc quad_perm:[1,1,1,1] row_mask:0xf bank_mask:0xf
    v_cndmask_b32_dpp v120, v156, v124, vcc quad_perm:[2,2,2,2] row_mask:0xf bank_mask:0xf
    v_cndmask_b32_dpp v121, v157, v124, vcc quad_perm:[2,2,2,2] row_mask:0xf bank_mask:0xf
    v_mfma_f32_16x16x32_bf16 v[136:139], v[116:119], v[116:119], 0
    v_cndmask_b32_dpp v122, v156, v124, vcc quad_perm:[3,3,3,3] row_mask:0xf bank_mask:0xf
    v_cndmask_b32_dpp v123, v157, v124, vcc quad_perm:[3,3,3,3] row_mask:0xf bank_mask:0xf
    v_smfmac_f32_16x16x64_bf16 v[132:135], v[116:119], v[36:43], v225
    s_nop 0
    v_mfma_f32_16x16x32_bf16 v[136:139], v[120:123], v[120:123], v[136:139]
    v_smfmac_f32_16x16x64_bf16 v[132:135], v[120:123], v[44:51], v225
    s_nop 6
    ds_write_b32 v10, v136
    ds_write2_b32 v9, v132, v133 offset0:0 offset1:64
    s_waitcnt lgkmcnt(0)
    s_barrier
    s_cmp_ge_u32 s5, 4
    s_cbranch_scc1 L_B_FPROG
    ds_read_b128 v[196:199], v12
    ds_read_b64 v[180:181], v11 offset:0
    ds_read_b64 v[182:183], v11 offset:512
    ds_read_b64 v[184:185], v11 offset:1024
    ds_read_b64 v[186:187], v11 offset:1536
    ds_read_b64 v[188:189], v11 offset:2048
    ds_read_b64 v[190:191], v11 offset:2560
    ds_read_b64 v[192:193], v11 offset:3072
    ds_read_b64 v[194:195], v11 offset:3584
    s_waitcnt lgkmcnt(8)
    v_pk_add_f32 v[164:165], v[196:197], v[198:199]
    s_nop 1
    v_add_f32_dpp v165, v165, v165 quad_perm:[1,0,3,2] row_mask:0xf bank_mask:0xf
    v_add_f32_dpp v164, v164, v164 quad_perm:[1,0,3,2] row_mask:0xf bank_mask:0xf
    s_nop 0
    v_add_f32_dpp v165, v165, v165 quad_perm:[2,3,0,1] row_mask:0xf bank_mask:0xf
    v_add_f32_dpp v164, v164, v164 quad_perm:[2,3,0,1] row_mask:0xf bank_mask:0xf
    v_mul_f32 v165, 0x3b000000, v165
    v_mul_f32 v164, 0x3b000000, v164
    s_waitcnt lgkmcnt(4)
    v_pk_add_f32 v[180:181], v[180:181], v[182:183]
    v_fma_f32 v164, -v165, v165, v164
    v_pk_add_f32 v[184:185], v[184:185], v[186:187]
    v_max_f32 v164, 0, v164
    v_pk_add_f32 v[180:181], v[180:181], v[184:185]
    v_add_f32 v164, 0x3727c5ac, v164
    v_fma_f32 v180, -v165, v176, v180
    v_rsq_f32 v164, v164
    v_fma_f32 v181, -v165, v177, v181
    s_waitcnt lgkmcnt(0)
    v_pk_add_f32 v[188:189], v[188:189], v[190:191]
    v_pk_add_f32 v[192:193], v[192:193], v[194:195]
    v_mul_f32 v165, 0xbfb8aa3b, v164
    v_pk_add_f32 v[180:181], v[180:181], v[188:189]
    v_pk_add_f32 v[160:161], v[180:181], v[192:193]
    v_pk_mul_f32 v[162:163], v[160:161], v[164:165] op_sel:[0,1] op_sel_hi:[1,1]
    v_pk_mul_f32 v[160:161], v[160:161], v[164:165] op_sel:[0,0] op_sel_hi:[1,0]
    v_exp_f32 v162, v162
    v_exp_f32 v163, v163
    v_add_f32 v162, 1.0, v162
    v_add_f32 v163, 1.0, v163
    v_rcp_f32 v162, v162
    v_rcp_f32 v163, v163
    v_mul_f32 v160, v160, v162
    v_mul_f32 v161, v161, v163
    v_cvt_pk_bf16_f32 v160, v160, v161
    s_nop 1
    v_mov_b32_dpp v116, v160 quad_perm:[0,0,0,0] row_mask:0xf bank_mask:0xf
    v_mov_b32_dpp v117, v160 quad_perm:[1,1,1,1] row_mask:0xf bank_mask:0xf
    v_mov_b32_dpp v118, v160 quad_perm:[2,2,2,2] row_mask:0xf bank_mask:0xf
    v_mov_b32_dpp v119, v160 quad_perm:[3,3,3,3] row_mask:0xf bank_mask:0xf
    s_nop 1
    v_smfmac_f32_16x16x64_bf16 v[68:71], v[116:119], v[84:91], v225
    v_smfmac_f32_16x16x64_bf16 v[72:75], v[116:119], v[92:99], v225
    v_smfmac_f32_16x16x64_bf16 v[76:79], v[116:119], v[100:107], v225
    v_smfmac_f32_16x16x64_bf16 v[80:83], v[116:119], v[108:115], v225
    s_nop 4
    v_cvt_pk_bf16_f32 v156, v68, v69
    v_cvt_pk_bf16_f32 v157, v72, v73
    v_min_u32 v156, -2, v156
    v_cvt_pk_bf16_f32 v158, v76, v77
    v_min_u32 v157, -2, v157
    v_cvt_pk_bf16_f32 v159, v80, v81
    v_min_u32 v158, -2, v158
    v_min_u32 v159, -2, v159
    buffer_store_dwordx4 v[156:159], v16, s[40:43], s72 offen sc1
    buffer_store_dwordx4 v[156:159], v16, s[40:43], s66 offen sc1
    s_branch L_B_SPARE2
L_B_PROBE:
    s_cmp_lg_u32 s5, 1
    s_cbranch_scc1 L_B_SPARE
    s_lshl_b32 s65, s3, 14
    s_add_u32 s65, s65, 0x169c00
    s_add_u32 s66, s65, 0x2000
    s_lshl_b32 s69, s3, 7
    s_add_u32 s69, s69, 0x2881c
    s_add_u32 s71, s69, 0xf4000
    s_mov_b32 s10, -1
    s_mov_b32 s72, -1
    s_mov_b32 s7, 0
    s_mov_b64 exec, 1
L_B_PROBE1:
    s_waitcnt vmcnt(0)
    s_memtime s[96:97]
    s_waitcnt lgkmcnt(0)
    buffer_store_dword v5, v5, s[40:43], s65 offen sc1
    s_waitcnt vmcnt(0)
    s_memtime s[98:99]
    s_waitcnt lgkmcnt(0)
    s_sub_u32 s9, s98, s96
    s_min_u32 s10, s10, s9
    s_waitcnt vmcnt(0)
    s_memtime s[96:97]
    s_waitcnt lgkmcnt(0)
    buffer_store_dword v5, v5, s[40:43], s66 offen sc1
    s_waitcnt vmcnt(0)
    s_memtime s[98:99]
    s_waitcnt lgkmcnt(0)
    s_sub_u32 s9, s98, s96
    s_min_u32 s72, s72, s9
    s_cmp_lt_u32 s72, s10
    s_cselect_b32 s8, 0x2000, 0
    v_mov_b32 v156, s8
    buffer_store_dword v156, v5, s[40:43], s69 offen
    buffer_store_dword v156, v5, s[40:43], s71 offen
    s_add_u32 s7, s7, 1
    s_cmp_lt_u32 s7, 3
    s_cbranch_scc1 L_B_PROBE1
    s_mov_b64 exec, -1
L_B_SPARE:
    s_barrier
L_B_SPARE3:
    s_cmp_lg_u32 s5, 0
    s_cbranch_scc1 QB_28
    s_add_u32 s8, s67, 0x31000
    buffer_store_dwordx4 v[212:215], v6, s[40:43], s8 offen sc1
QB_28:
    s_branch L_B_NEXT
L_B_FPROG:
    s_cmp_lg_u32 s5, 4
    s_cbranch_scc1 L_B_SPARE2
    s_lshl_b32 s8, s3, 7
    s_lshl_b32 s9, s64, 2
    s_add_u32 s8, s8, s9
    s_add_u32 s8, s8, s6
    s_add_u32 s8, s8, s15
    s_add_u32 s8, s8, 0x28800
    buffer_store_dword v5, v5, s[40:43], s8 offen
L_B_SPARE2:
    s_barrier
    s_branch L_B_NEXT
L_B_O:
    s_cmp_lg_u32 s6, 0
    s_cbranch_scc1 L_B_OGO
    s_lshl_b32 s66, s3, 19
    s_lshl_b32 s8, s5, 16
    s_add_u32 s66, s66, s8
    s_sub_u32 s8, s64, 8
    s_lshl_b32 s8, s8, 7
    s_add_u32 s66, s66, s8
    v_lshrrev_b32 v160, 3, v1
    v_and_b32 v161, 7, v1
    v_lshlrev_b32 v15, 4, v161
    v_lshl_add_u32 v15, v160, 10, v15
    s_lshl_b32 s8, s3, 19
    s_lshl_b32 s9, s64, 16
    s_add_u32 s8, s8, s9
    s_lshl_b32 s9, s5, 12
    s_add_u32 s8, s8, s9
    s_sub_u32 s8, s8, 0x80000
    s_add_u32 s9, s8, 0x8000
    v_lshlrev_b32 v156, 4, v1
    buffer_load_dwordx4 v[84:87], v156, s[52:55], s9 offen offset:0
    buffer_load_dwordx4 v[88:91], v156, s[52:55], s9 offen offset:1024
    buffer_load_dwordx4 v[92:95], v156, s[52:55], s9 offen offset:2048
    buffer_load_dwordx4 v[96:99], v156, s[52:55], s9 offen offset:3072
    s_lshl_b32 s8, s5, 13
    s_add_u32 s8, s8, 0x8000
    v_add_u32 v164, s8, v8
    s_lshl_b32 s69, s3, 14
    s_lshl_b32 s9, s5, 11
    s_add_u32 s69, s69, s9
    s_add_u32 s69, s69, 0x8000
    v_lshlrev_b32 v4, 4, v1
    v_add_u32 v4, s69, v4
    s_lshl_b32 s69, s3, 8
    s_lshr_b32 s8, s5, 1
    s_lshl_b32 s9, s8, 6
    s_add_u32 s69, s69, s9
    s_add_u32 s69, s69, 0x28000
    v_lshlrev_b32 v8, 4, v3
    v_add_u32 v8, s69, v8
    s_lshl_b32 s8, s5, 10
    s_add_u32 s8, s8, 0x18000
    v_lshlrev_b32 v18, 2, v2
    v_lshl_add_u32 v18, v3, 8, v18
    v_add_u32 v18, s8, v18
    s_lshl_b32 s8, s5, 9
    v_add_u32 v17, s8, v11
    v_lshlrev_b32 v16, 2, v2
    v_and_b32 v156, 1, v3
    v_lshl_add_u32 v16, v156, 10, v16
    v_lshrrev_b32 v156, 1, v3
    v_lshl_add_u32 v16, v156, 6, v16
    s_and_b32 s72, s64, 6
    s_lshl_b32 s72, s72, 13
    s_and_b32 s8, s64, 1
    s_lshl_b32 s8, s8, 12
    s_add_u32 s72, s72, s8
    s_lshr_b32 s8, s3, 2
    s_lshl_b32 s8, s8, 11
    s_add_u32 s72, s72, s8
    s_and_b32 s8, s3, 3
    s_lshl_b32 s8, s8, 8
    s_add_u32 s72, s72, s8
    s_lshl_b32 s8, s5, 7
    s_add_u32 s72, s72, s8
    s_add_u32 s72, s72, 0x64000
    v_and_b32 v156, 3, v1
    v_mov_b32 v157, 0x40000000
    v_cmp_eq_u32 vcc, 0, v156
    s_nop 1
    v_cndmask_b32 v16, v157, v16, vcc
    s_cmp_ge_u32 s5, 2
    s_cbranch_scc1 SI_29
    v_mov_b32 v168, -1
    v_mov_b32 v169, -1
    v_mov_b32 v170, -1
    v_mov_b32 v171, -1
    s_add_u32 s8, s72, 0xf4000
    s_add_u32 s9, s72, 0xf6000
    buffer_store_dwordx4 v[168:171], v16, s[40:43], s8 offen sc1
    buffer_store_dwordx4 v[168:171], v16, s[40:43], s9 offen sc1
SI_29:
    v_mov_b32 v108, -1
    v_mov_b32 v109, -1
    v_mov_b32 v110, -1
    v_mov_b32 v111, -1
    v_lshlrev_b32 v107, 4, v1
    v_mov_b32 v157, 0x40000000
    v_cmp_gt_u32 vcc, 56, v1
    s_nop 1
    v_cndmask_b32 v107, v157, v107, vcc
    s_and_b32 s8, s5, 3
    s_lshl_b32 s8, s8, 3
    s_add_u32 s8, s8, s64
    s_lshl_b32 s8, s8, 14
    s_mul_i32 s9, s3, 896
    s_add_u32 s8, s8, s9
    s_lshr_b32 s9, s5, 2
    s_lshl_b32 s9, s9, 13
    s_add_u32 s8, s8, s9
    s_add_u32 s71, s8, 0x54000
    buffer_store_dwordx4 v[108:111], v107, s[40:43], s71 offen sc1
    s_waitcnt vmcnt(1)
    buffer_load_dword v19, v5, s[60:63], s11 offen offset:96 sc1
    s_lshl_b32 s9, s5, 13
    s_add_u32 s9, s9, 32768
    s_mov_b32 m0, s9
    s_add_u32 s8, s66, 0
    buffer_load_dwordx4 v15, s[52:55], s8 offen offset:0  lds
    s_add_u32 s8, s66, 7168
    buffer_load_dwordx4 v15, s[52:55], s8 offen offset:1024  lds
    s_add_u32 s8, s66, 14336
    buffer_load_dwordx4 v15, s[52:55], s8 offen offset:2048  lds
    s_add_u32 s8, s66, 21504
    buffer_load_dwordx4 v15, s[52:55], s8 offen offset:3072  lds
    s_lshl_b32 s9, s5, 13
    s_add_u32 s9, s9, 36864
    s_mov_b32 m0, s9
    s_add_u32 s8, s66, 32768
    buffer_load_dwordx4 v15, s[52:55], s8 offen offset:0  lds
    s_add_u32 s8, s66, 39936
    buffer_load_dwordx4 v15, s[52:55], s8 offen offset:1024  lds
    s_add_u32 s8, s66, 47104
    buffer_load_dwordx4 v15, s[52:55], s8 offen offset:2048  lds
    s_add_u32 s8, s66, 54272
    buffer_load_dwordx4 v15, s[52:55], s8 offen offset:3072  lds
    v_mov_b32 v15, v4
    s_waitcnt vmcnt(8)
    v_cmp_gt_u32 vcc, 2, v19
    s_cbranch_vccz FOK_30
    s_mov_b32 s7, 0
FLAG_31:
    buffer_load_dword v19, v5, s[60:63], s11 offen offset:96 sc1
    s_add_u32 s7, s7, 1
    s_cmp_gt_u32 s7, 0x200000
    s_cbranch_scc1 L_END
    s_waitcnt vmcnt(0)
    v_cmp_gt_u32 vcc, 2, v19
    s_cbranch_vccz FLAGD_32
    s_sleep 1
    s_and_b32 s8, s7, 255
    s_or_b32 s8, s8, s13
    s_cbranch_scc1 FLAG_31
    buffer_load_dword v19, v5, s[60:63], 0 offen offset:128 sc1
    s_waitcnt vmcnt(0)
    v_cmp_ne_u32 vcc, 64, v19
    s_cbranch_vccnz FLAG_31
FLAGD_32:
FOK_30:
    s_waitcnt vmcnt(0)
    s_cmp_lg_u32 s5, 0
    s_cbranch_scc1 QB_33
    s_add_u32 s8, s67, 0x31000
    buffer_store_dwordx4 v[212:215], v6, s[40:43], s8 offen sc1
QB_33:
    ds_read_b64_tr_b16 v[36:37], v164 offset:0
    ds_read_b64_tr_b16 v[38:39], v164 offset:512
    ds_read_b64_tr_b16 v[40:41], v164 offset:32
    ds_read_b64_tr_b16 v[42:43], v164 offset:544
    ds_read_b64_tr_b16 v[44:45], v164 offset:64
    ds_read_b64_tr_b16 v[46:47], v164 offset:576
    ds_read_b64_tr_b16 v[48:49], v164 offset:96
    ds_read_b64_tr_b16 v[50:51], v164 offset:608
    ds_read_b64_tr_b16 v[52:53], v164 offset:4096
    ds_read_b64_tr_b16 v[54:55], v164 offset:4608
    ds_read_b64_tr_b16 v[56:57], v164 offset:4128
    ds_read_b64_tr_b16 v[58:59], v164 offset:4640
    ds_read_b64_tr_b16 v[60:61], v164 offset:4160
    ds_read_b64_tr_b16 v[62:63], v164 offset:4672
    ds_read_b64_tr_b16 v[64:65], v164 offset:4192
    ds_read_b64_tr_b16 v[66:67], v164 offset:4704
    s_waitcnt lgkmcnt(0)
    s_branch L_B_OGO2
L_B_OGO:
    s_cmp_lg_u32 s5, 0
    s_cbranch_scc1 QB_34
    s_add_u32 s8, s67, 0x31000
    buffer_store_dwordx4 v[212:215], v6, s[40:43], s8 offen sc1
QB_34:
    buffer_store_dwordx4 v[108:111], v107, s[40:43], s71 offen sc1
L_B_OGO2:
    s_lshl_b32 s70, s3, 7
    s_lshl_b32 s9, s64, 2
    s_add_u32 s70, s70, s9
    s_add_u32 s70, s70, s6
    s_add_u32 s70, s70, s15
    s_add_u32 s70, s70, 0x28800
    s_cmp_lg_u32 s5, 0
    s_cselect_b32 s70, 0x40000000, s70
    buffer_load_dwordx4 v[68:71], v15, s[40:43], s6 offen offset:0 sc1
    buffer_load_dwordx4 v[72:75], v15, s[40:43], s6 offen offset:1024 sc1
    s_mov_b32 s7, 0
    s_add_u32 s10, s6, s14
POLL_35:
    buffer_load_dwordx4 v[76:79], v8, s[40:43], s10 offen sc1
    s_add_u32 s7, s7, 1
    s_and_b32 s8, s7, s13
    s_cmp_eq_u32 s8, s13
    s_cselect_b32 s8, 0x31000, 0
    s_add_u32 s10, s6, s8
    s_cmp_gt_u32 s7, 0x200000
    s_cbranch_scc1 L_END
    s_waitcnt vmcnt(0)
    v_max3_u32 v156, v76, v77, v78
    v_max_u32 v156, v156, v79
    v_cmp_eq_u32 vcc, -1, v156
    s_cbranch_vccnz POLL_35
    s_mov_b32 s7, 0
    s_add_u32 s10, s6, s14
POLL_36:
    buffer_load_dwordx4 v[68:71], v15, s[40:43], s10 offen offset:0 sc1
    buffer_load_dwordx4 v[72:75], v15, s[40:43], s10 offen offset:1024 sc1
    s_add_u32 s7, s7, 1
    s_and_b32 s8, s7, s13
    s_cmp_eq_u32 s8, s13
    s_cselect_b32 s8, 0x31000, 0
    s_add_u32 s10, s6, s8
    s_cmp_gt_u32 s7, 0x200000
    s_cbranch_scc1 L_END
    v_max3_f32 v156, v76, v77, v78
    v_max_f32 v156, v156, v79
    v_sub_f32 v80, v76, v156
    v_sub_f32 v81, v77, v156
    v_sub_f32 v82, v78, v156
    v_sub_f32 v83, v79, v156
    v_exp_f32 v80, v80
    v_exp_f32 v81, v81
    v_exp_f32 v82, v82
    v_exp_f32 v83, v83
    v_add_f32 v156, v80, v81
    v_add_f32 v157, v82, v83
    v_add_f32 v156, v156, v157
    v_rcp_f32 v156, v156
    s_nop 0
    v_mul_f32 v80, v80, v156
    v_mul_f32 v81, v81, v156
    v_mul_f32 v82, v82, v156
    v_mul_f32 v83, v83, v156
    s_waitcnt vmcnt(1)
    v_mfma_f32_16x16x32_bf16 v[128:131], v[68:71], v[36:39], 0
    v_mfma_f32_16x16x32_bf16 v[132:135], v[68:71], v[40:43], 0
    v_mfma_f32_16x16x32_bf16 v[136:139], v[68:71], v[44:47], 0
    v_mfma_f32_16x16x32_bf16 v[140:143], v[68:71], v[48:51], 0
    v_max3_u32 v156, v68, v69, v70
    v_max_u32 v156, v156, v71
    s_waitcnt vmcnt(0)
    v_mfma_f32_16x16x32_bf16 v[128:131], v[72:75], v[52:55], v[128:131]
    v_mfma_f32_16x16x32_bf16 v[132:135], v[72:75], v[56:59], v[132:135]
    v_mfma_f32_16x16x32_bf16 v[136:139], v[72:75], v[60:63], v[136:139]
    v_mfma_f32_16x16x32_bf16 v[140:143], v[72:75], v[64:67], v[140:143]
    v_max3_u32 v156, v156, v72, v73
    v_max3_u32 v156, v156, v74, v75
    v_cmp_eq_u32 vcc, -1, v156
    s_cbranch_vccnz POLL_36
    s_nop 0
    v_pk_mul_f32 v[128:129], v[128:129], v[80:81]
    v_pk_fma_f32 v[128:129], v[130:131], v[82:83], v[128:129]
    v_add_f32 v128, v128, v129
    v_pk_mul_f32 v[132:133], v[132:133], v[80:81]
    v_pk_fma_f32 v[132:133], v[134:135], v[82:83], v[132:133]
    v_add_f32 v132, v132, v133
    ds_write2_b32 v18, v128, v132 offset0:0 offset1:16
    v_pk_mul_f32 v[136:137], v[136:137], v[80:81]
    v_pk_fma_f32 v[136:137], v[138:139], v[82:83], v[136:137]
    v_add_f32 v136, v136, v137
    v_pk_mul_f32 v[140:141], v[140:141], v[80:81]
    v_pk_fma_f32 v[140:141], v[142:143], v[82:83], v[140:141]
    v_add_f32 v140, v140, v141
    ds_write2_b32 v18, v136, v140 offset0:32 offset1:48
    s_waitcnt lgkmcnt(0)
    s_barrier
    s_cmp_ge_u32 s5, 2
    s_cbranch_scc1 L_B_SPARE2
    ds_read_b64 v[180:181], v17 offset:0
    ds_read_b64 v[182:183], v17 offset:1024
    ds_read_b64 v[184:185], v17 offset:2048
    ds_read_b64 v[186:187], v17 offset:3072
    ds_read_b64 v[188:189], v17 offset:4096
    ds_read_b64 v[190:191], v17 offset:5120
    ds_read_b64 v[192:193], v17 offset:6144
    ds_read_b64 v[194:195], v17 offset:7168
    s_add_u32 s66, s72, 0x2000
    s_waitcnt lgkmcnt(0)
    v_pk_add_f32 v[180:181], v[180:181], v[182:183]
    v_pk_add_f32 v[184:185], v[184:185], v[186:187]
    v_pk_add_f32 v[188:189], v[188:189], v[190:191]
    v_pk_add_f32 v[192:193], v[192:193], v[194:195]
    v_pk_add_f32 v[180:181], v[180:181], v[184:185]
    v_pk_add_f32 v[188:189], v[188:189], v[192:193]
    v_pk_add_f32 v[156:157], v[180:181], v[188:189]
    v_cvt_pk_bf16_f32 v156, v156, v157
    v_min_u32 v156, -2, v156
    buffer_store_dword v5, v5, s[40:43], s70 offen
    s_nop 0
    v_mov_b32_dpp v157, v156 quad_perm:[1,1,1,1] row_mask:0xf bank_mask:0xf
    v_mov_b32_dpp v158, v156 quad_perm:[2,2,2,2] row_mask:0xf bank_mask:0xf
    v_mov_b32_dpp v159, v156 quad_perm:[3,3,3,3] row_mask:0xf bank_mask:0xf
    buffer_store_dwordx4 v[156:159], v16, s[40:43], s72 offen sc1
    buffer_store_dwordx4 v[156:159], v16, s[40:43], s66 offen sc1
    s_barrier
L_B_NEXT:
    s_cmp_lg_u32 s6, 0
    s_cbranch_scc1 L_END
    s_mov_b32 s6, 0xf4000
    s_add_u32 s67, s67, 0xf4000
    s_add_u32 s71, s71, 0xf4000
    s_add_u32 s72, s72, 0xf4000
    s_lshl_b32 s8, s3, 12
    s_add_u32 s68, s68, s8
    s_add_u32 s68, s68, 0x29000
    s_branch L_B_LOOP
L_END:
    s_endpgm
.section .rodata,"a"
.p2align 6
.amdhsa_kernel interleave_layers__sliding_block_cached__dense_activation_silu__decode_kernel
  .amdhsa_next_free_vgpr 256
  .amdhsa_next_free_sgpr 102
  .amdhsa_accum_offset 256
  .amdhsa_group_segment_fixed_size 0
  .amdhsa_kernarg_size 88
  .amdhsa_user_sgpr_count 2
  .amdhsa_user_sgpr_kernarg_segment_ptr 1
  .amdhsa_system_sgpr_workgroup_id_x 1
  .amdhsa_float_denorm_mode_32 3
.end_amdhsa_kernel
```
